```python
import torch

def _softmax(x, axis=-1):
    return torch.softmax(x, dim=axis)

def _gelu(x):
    return torch.nn.functional.gelu(x, approximate='tanh')

def _silu(x):
    return torch.nn.functional.silu(x)

def _sigmoid(x):
    return torch.sigmoid(x)

def _layernorm(x, axis=-1, eps=1e-05):
    m = x.mean(dim=axis, keepdim=True)
    v = x.var(dim=axis, keepdim=True, unbiased=False)
    return (x - m) / torch.sqrt(v + eps)

def _scatter_add(tgt, idx, src, axis=0):
    return tgt.clone().index_add_(axis, idx, src)

def _segment_sum(src, seg, n):
    out = torch.zeros((n,) + src.shape[1:], dtype=src.dtype)
    return out.index_add_(0, seg, src)

def _pad(x, pw):
    flat = tuple((v for pair in reversed(pw) for v in pair))
    return torch.nn.functional.pad(x, flat)
kernel_name = 'standalone__kv_cache_quant_pre_rope_vs_post_rope__sampling'

def setup_inputs():

    _w = lambda a: (lambda t: t.to(torch.bfloat16) if t.is_floating_point() else t)(torch.as_tensor(a))
    B, Sq, Skv = (16, 8, 4096)
    H, Dh0 = (4, 128)
    G = 128 if 128 > 0 else Dh0
    G = max(2, G // 2 * 2)
    Dh = max(G, Dh0 // G * G)
    Skv = max(Skv, Sq)
    ng = Dh // G
    bits = 2 if 2 > 1 else 4
    bits = max(2, min(8, bits))
    qmax = (1 << bits) - 1
    half = Dh // 2
    inv = 1.0 / 10000.0 ** (torch.arange(half) / max(1, half))
    ang_k = torch.arange(Skv)[:, None] * inv[None, :]
    ang_q = torch.arange(Skv - Sq, Skv)[:, None] * inv[None, :]
    kc = torch.cat([torch.cos(ang_k), torch.cos(ang_k)], dim=-1)
    ks = torch.cat([torch.sin(ang_k), torch.sin(ang_k)], dim=-1)
    qc = torch.cat([torch.cos(ang_q), torch.cos(ang_q)], dim=-1)
    qs = torch.cat([torch.sin(ang_q), torch.sin(ang_q)], dim=-1)
    qk_i = torch.randint(0, qmax + 1, (B, H, Skv, Dh)).to(torch.int32)
    qv_i = torch.randint(0, qmax + 1, (B, H, Skv, Dh)).to(torch.int32)
    ksc = torch.abs((lambda *s: torch.randn(*s, dtype=torch.bfloat16) * 0.4)(B, H, Skv, ng)) * 0.1 + 0.01
    kzp = torch.full((B, H, Skv, ng), qmax / 2.0)
    vsc = torch.abs((lambda *s: torch.randn(*s, dtype=torch.bfloat16) * 0.4)(B, H, Skv, ng)) * 0.1 + 0.01
    vzp = torch.full((B, H, Skv, ng), qmax / 2.0)
    return {'q': _w((lambda *s: torch.randn(*s, dtype=torch.bfloat16) * 6.4)(B, H, Sq, Dh) * 0.5), 'qk': _w(qk_i), 'k_scales': _w(ksc), 'k_zeros': _w(kzp), 'qv': _w(qv_i), 'v_scales': _w(vsc), 'v_zeros': _w(vzp), 'q_cos': _w(qc), 'q_sin': _w(qs), 'k_cos': _w(kc), 'k_sin': _w(ks)}

def reference(q, qk, k_scales, k_zeros, qv, v_scales, v_zeros, q_cos, q_sin, k_cos, k_sin):
    B, H, Sq, Dh = q.shape
    ng = k_scales.shape[-1]
    G = Dh // ng
    half = Dh // 2
    ks = (lambda x, n, axis: torch.repeat_interleave(x, n, dim=axis))(k_scales, G, axis=-1)
    kz = (lambda x, n, axis: torch.repeat_interleave(x, n, dim=axis))(k_zeros, G, axis=-1)
    k = ((lambda x, dt: x.to(dt))(qk, q.dtype) - kz) * ks
    vs = (lambda x, n, axis: torch.repeat_interleave(x, n, dim=axis))(v_scales, G, axis=-1)
    vz = (lambda x, n, axis: torch.repeat_interleave(x, n, dim=axis))(v_zeros, G, axis=-1)
    v = ((lambda x, dt: x.to(dt))(qv, q.dtype) - vz) * vs
    k1 = k[..., :half].clone()
    k2 = k[..., half:].clone()
    krh = torch.concatenate([-k2, k1], axis=-1)
    kr = k * k_cos[None, None, :, :] + krh * k_sin[None, None, :, :]
    q1 = q[..., :half].clone()
    q2 = q[..., half:].clone()
    qrh = torch.concatenate([-q2, q1], axis=-1)
    qr = q * q_cos[None, None, :, :] + qrh * q_sin[None, None, :, :]
    logits = torch.einsum('bhqd,bhkd->bhqk', qr, kr) * float(Dh) ** (-0.5)
    attn = _softmax(logits, axis=-1)
    out = torch.einsum('bhqk,bhkd->bhqd', attn, v)
    return out
```

```asm
; @launch grid=(256,1,1) block=(320,1,1) lds=71296
.amdgcn_target "amdgcn-amd-amdhsa--gfx950"
.text
.globl standalone__kv_cache_quant_pre_rope_vs_post_rope__sampling_kernel
.p2align 8
.type standalone__kv_cache_quant_pre_rope_vs_post_rope__sampling_kernel,@function
standalone__kv_cache_quant_pre_rope_vs_post_rope__sampling_kernel:
  s_load_dwordx16 s[4:19], s[0:1], 0
  s_load_dwordx8 s[20:27], s[0:1], 64
  s_load_dwordx4 s[28:31], s[0:1], 96
  s_cmpk_ge_u32 s2, 256
  s_cbranch_scc1 L_end
  v_readfirstlane_b32 s3, v0
  v_and_b32 v1, 15, v0
  v_bfe_u32 v2, v0, 4, 2
  v_lshlrev_b32 v3, 4, v1
  v_lshl_add_u32 v3, v2, 11, v3
  s_lshr_b32 s3, s3, 6
  s_cmp_eq_u32 s3, 4
  s_cbranch_scc1 L_helper
  s_andn2_b32 s54, s2, 15
  s_and_b32 s55, s2, 3
  s_lshl2_add_u32 s54, s55, s54
  s_add_u32 s54, s54, s3
  s_lshl_b32 s62, s54, 13
  s_lshr_b32 s60, s2, 2
  s_lshl_b32 s61, s60, 21
  s_add_u32 s48, s62, s61
  s_lshl_b32 s34, 1, 27
  s_mov_b32 s35, 0x20000
  s_waitcnt lgkmcnt(0)
  s_mov_b64 s[32:33], s[6:7]
  buffer_load_dwordx4 v[88:91], v3, s[32:35], s48 offen offset:0 nt
  buffer_load_dwordx4 v[92:95], v3, s[32:35], s48 offen offset:256 nt
  buffer_load_dwordx4 v[96:99], v3, s[32:35], s48 offen offset:512 nt
  buffer_load_dwordx4 v[100:103], v3, s[32:35], s48 offen offset:768 nt
  s_lshr_b32 s54, s2, 4
  v_lshrrev_b32 v13, 4, v0
  v_add_u32 v13, s54, v13
  v_and_b32 v13, 15, v13
  v_lshlrev_b32 v13, 9, v13
  v_lshl_add_u32 v13, v1, 3, v13
  s_lshl_b32 s54, s60, 13
  s_lshl_b32 s55, s55, 7
  s_add_u32 s54, s54, s55
  v_add_u32 v13, s54, v13
  v_lshrrev_b32 v20, 5, v0
  v_and_b32 v12, 31, v0
  v_lshlrev_b32 v14, 8, v20
  v_lshl_add_u32 v14, v12, 2, v14
  s_lshl_b32 s71, s60, 11
  s_add_u32 s4, s4, s71
  s_addc_u32 s5, s5, 0
  global_load_dwordx2 v[184:185], v13, s[8:9]
  global_load_dwordx2 v[186:187], v13, s[10:11]
  global_load_dwordx2 v[188:189], v13, s[14:15]
  global_load_dwordx2 v[190:191], v13, s[16:17]
  global_load_dword v192, v14, s[4:5] offset:0
  global_load_dword v193, v14, s[4:5] offset:128
  global_load_dword v194, v14, s[18:19] offset:0
  global_load_dword v195, v14, s[18:19] offset:128
  global_load_dword v196, v14, s[20:21] offset:0
  global_load_dword v197, v14, s[20:21] offset:128
  v_lshrrev_b32 v4, 1, v3
  s_lshr_b32 s49, s62, 1
  s_mov_b64 s[40:41], s[22:23]
  s_lshl_b32 s42, 1, 20
  s_mov_b32 s43, s35
  s_mov_b64 s[44:45], s[24:25]
  s_mov_b64 s[46:47], s[42:43]
  s_mov_b64 s[36:37], s[12:13]
  s_mov_b64 s[38:39], s[34:35]
  buffer_load_dwordx2 v[120:121], v4, s[40:43], s49 offen offset:0
  s_mov_b32 s51, 0x05040100
  s_mov_b32 s52, 0x07060302
  s_mov_b32 s53, 0x3e0293ee
  s_mov_b64 s[56:57], s[30:31]
  s_mov_b32 s58, 1310720
  s_mov_b32 s59, s35
  s_mul_i32 s64, s2, 5120
  buffer_load_dwordx2 v[122:123], v4, s[44:47], s49 offen offset:0
  s_xor_b32 s54, s2, 1
  s_mul_i32 s65, s54, 5120
  s_xor_b32 s54, s2, 2
  s_mul_i32 s66, s54, 5120
  s_xor_b32 s54, s2, 3
  s_mul_i32 s67, s54, 5120
  v_mul_u32_u24 v16, 640, v20
  buffer_load_dwordx2 v[124:125], v4, s[40:43], s49 offen offset:256
  v_lshl_add_u32 v15, v12, 4, v16
  v_mul_u32_u24 v19, 528, v20
  v_lshl_add_u32 v19, v12, 4, v19
  v_mul_u32_u24 v14, 272, v20
  v_lshlrev_b32 v20, 3, v20
  v_and_b32 v13, 30, v0
  v_lshl_add_u32 v14, v13, 3, v14
  buffer_load_dwordx2 v[126:127], v4, s[44:47], s49 offen offset:256
  v_and_b32 v13, 1, v0
  v_lshl_add_u32 v14, v13, 2, v14
  s_mul_i32 s54, s3, 4352
  v_mul_u32_u24 v5, 1088, v2
  v_lshl_add_u32 v5, v1, 4, v5
  v_add_u32 v5, s54, v5
  v_mul_u32_u24 v6, 272, v1
  buffer_load_dwordx4 v[104:107], v3, s[32:35], s48 offen offset:1024 nt
  v_lshl_add_u32 v6, v2, 6, v6
  v_add_u32 v6, s54, v6
  v_and_b32 v12, 7, v1
  v_lshl_add_u32 v18, v12, 3, s54
  v_mul_u32_u24 v17, 528, v12
  v_lshl_add_u32 v17, v2, 6, v17
  v_lshrrev_b32 v13, 3, v1
  buffer_load_dwordx2 v[128:129], v4, s[40:43], s49 offen offset:512
  v_lshl_add_u32 v17, v13, 8, v17
  v_add_u32 v17, s54, v17
  v_mul_u32_u24 v22, 272, v12
  v_lshl_add_u32 v22, v2, 6, v22
  s_lshl_b32 s54, s3, 13
  v_lshl_add_u32 v21, v12, 4, s54
  v_lshl_add_u32 v21, v2, 7, v21
  buffer_load_dwordx4 v[108:111], v3, s[32:35], s48 offen offset:1280 nt
  s_lshl_b32 s54, s3, 7
  v_lshl_add_u32 v7, v2, 5, s54
  v_lshlrev_b32 v13, 5, v0
  v_mov_b32 v8, 0xff61b1e6
  s_mov_b32 s50, 16
  s_mov_b32 s73, 1
  s_mov_b64 vcc, 0
  buffer_load_dwordx2 v[130:131], v4, s[44:47], s49 offen offset:512
  s_waitcnt vmcnt(14)
  v_lshlrev_b32 v164, 16, v184
  v_lshlrev_b32 v165, 16, v186
  v_mul_f32 v165, -v164, v165
  v_and_b32 v166, 0xffff0000, v184
  v_and_b32 v167, 0xffff0000, v186
  v_mul_f32 v167, -v166, v167
  ds_write_b128 v13, v[164:167] offset:17408
  buffer_load_dwordx4 v[112:115], v3, s[32:35], s48 offen offset:1536 nt
  v_lshlrev_b32 v168, 16, v185
  v_lshlrev_b32 v169, 16, v187
  v_mul_f32 v169, -v168, v169
  v_and_b32 v170, 0xffff0000, v185
  v_and_b32 v171, 0xffff0000, v187
  v_mul_f32 v171, -v170, v171
  ds_write_b128 v13, v[168:171] offset:17424
  buffer_load_dwordx2 v[132:133], v4, s[40:43], s49 offen offset:768
  v_lshlrev_b32 v172, 16, v188
  v_lshlrev_b32 v173, 16, v190
  v_mul_f32 v173, -v172, v173
  v_and_b32 v174, 0xffff0000, v188
  v_and_b32 v175, 0xffff0000, v190
  v_mul_f32 v175, -v174, v175
  ds_write_b128 v13, v[172:175] offset:26112
  buffer_load_dwordx4 v[116:119], v3, s[32:35], s48 offen offset:1792 nt
  v_lshlrev_b32 v176, 16, v189
  v_lshlrev_b32 v177, 16, v191
  v_mul_f32 v177, -v176, v177
  v_and_b32 v178, 0xffff0000, v189
  v_and_b32 v179, 0xffff0000, v191
  v_mul_f32 v179, -v178, v179
  ds_write_b128 v13, v[176:179] offset:26128
  buffer_load_dwordx2 v[134:135], v4, s[44:47], s49 offen offset:768
  s_waitcnt vmcnt(12)
  v_perm_b32 v180, v193, v192, s51
  v_perm_b32 v200, v196, v194, s51
  v_perm_b32 v202, v195, v197, s51
  v_perm_b32 v181, v193, v192, s52
  v_perm_b32 v201, v196, v194, s52
  v_perm_b32 v203, v195, v197, s52
  v_dot2_f32_bf16 v200, v180, v200, 0 neg_hi:[0,1,0]
  v_dot2_f32_bf16 v201, v181, v201, 0 neg_hi:[0,1,0]
  v_dot2_f32_bf16 v202, v180, v202, 0
  v_dot2_f32_bf16 v203, v181, v203, 0
  s_nop 2
  v_cvt_pk_bf16_f32 v180, v200, v201
  v_cvt_pk_bf16_f32 v181, v202, v203
  ds_write_b32 v14, v180 offset:35328
  ds_write_b32 v14, v181 offset:35336
  s_waitcnt lgkmcnt(0)
  s_barrier
  ds_read_b128 v[140:143], v7 offset:17408
  ds_read_b128 v[144:147], v7 offset:17424
  v_add_u32 v7, 512, v7
  ds_read_b128 v[148:151], v22 offset:35328
  ds_read_b128 v[152:155], v22 offset:35344
  ds_read_b128 v[156:159], v22 offset:35360
  ds_read_b128 v[160:163], v22 offset:35376
  s_mov_b32 s63, s49
  s_add_u32 s62, s62, 0x20000
  s_and_b32 s62, s62, 0x1fffff
  s_add_u32 s48, s62, s61
  s_lshr_b32 s49, s62, 1
  s_waitcnt vmcnt(10)
L_kloop:
  s_waitcnt vmcnt(12) lgkmcnt(0)
  v_cvt_f32_i32 v164, v88
  v_cvt_f32_i32 v165, v89
  v_cvt_f32_i32 v166, v90
  v_cvt_f32_i32 v167, v91
  v_cvt_f32_i32 v168, v92
  v_cvt_f32_i32 v169, v93
  v_cvt_f32_i32 v170, v94
  v_cvt_f32_i32 v171, v95
  v_perm_b32 v172, v122, v120, s51
  v_perm_b32 v173, v122, v120, s52
  v_perm_b32 v174, v123, v121, s51
  v_perm_b32 v175, v123, v121, s52
  s_cbranch_vccnz L_both0
  v_perm_b32 v176, v120, v122, s51
  v_perm_b32 v177, v120, v122, s52
  v_perm_b32 v178, v121, v123, s51
  v_perm_b32 v179, v121, v123, s52
L_back0:
  buffer_load_dwordx4 v[88:91], v3, s[32:35], s48 offen offset:0 nt
  buffer_load_dwordx2 v[120:121], v4, s[40:43], s49 offen offset:0
  buffer_load_dwordx4 v[92:95], v3, s[32:35], s48 offen offset:256 nt
  buffer_load_dwordx2 v[122:123], v4, s[44:47], s49 offen offset:0
  v_pk_fma_f32 v[164:165], v[164:165], v[140:141], v[140:141] op_sel:[0,0,1] op_sel_hi:[1,0,1]
  v_pk_fma_f32 v[166:167], v[166:167], v[140:141], v[140:141] op_sel:[0,0,1] op_sel_hi:[1,0,1]
  v_pk_fma_f32 v[168:169], v[168:169], v[140:141], v[140:141] op_sel:[0,0,1] op_sel_hi:[1,0,1]
  v_pk_fma_f32 v[170:171], v[170:171], v[140:141], v[140:141] op_sel:[0,0,1] op_sel_hi:[1,0,1]
  v_cvt_pk_bf16_f32 v164, v164, v168
  v_cvt_pk_bf16_f32 v165, v165, v169
  v_cvt_pk_bf16_f32 v166, v166, v170
  v_cvt_pk_bf16_f32 v167, v167, v171
  v_dot2_f32_bf16 v172, v164, v172, 0 neg_hi:[0,1,0]
  v_dot2_f32_bf16 v173, v165, v173, 0 neg_hi:[0,1,0]
  v_dot2_f32_bf16 v174, v166, v174, 0 neg_hi:[0,1,0]
  v_dot2_f32_bf16 v175, v167, v175, 0 neg_hi:[0,1,0]
  v_dot2_f32_bf16 v176, v164, v176, 0
  v_dot2_f32_bf16 v177, v165, v177, 0
  v_dot2_f32_bf16 v178, v166, v178, 0
  v_dot2_f32_bf16 v179, v167, v179, 0
  v_cvt_pk_bf16_f32 v180, v172, v173
  v_cvt_pk_bf16_f32 v181, v174, v175
  v_cvt_pk_bf16_f32 v182, v176, v177
  v_cvt_pk_bf16_f32 v183, v178, v179
  ds_write_b128 v5, v[180:183] offset:0
  s_waitcnt vmcnt(12)
  v_cvt_f32_i32 v164, v96
  v_cvt_f32_i32 v165, v97
  v_cvt_f32_i32 v166, v98
  v_cvt_f32_i32 v167, v99
  v_cvt_f32_i32 v168, v100
  v_cvt_f32_i32 v169, v101
  v_cvt_f32_i32 v170, v102
  v_cvt_f32_i32 v171, v103
  v_perm_b32 v172, v126, v124, s51
  v_perm_b32 v173, v126, v124, s52
  v_perm_b32 v174, v127, v125, s51
  v_perm_b32 v175, v127, v125, s52
  s_cbranch_vccnz L_both1
  v_perm_b32 v176, v124, v126, s51
  v_perm_b32 v177, v124, v126, s52
  v_perm_b32 v178, v125, v127, s51
  v_perm_b32 v179, v125, v127, s52
L_back1:
  buffer_load_dwordx4 v[96:99], v3, s[32:35], s48 offen offset:512 nt
  buffer_load_dwordx2 v[124:125], v4, s[40:43], s49 offen offset:256
  buffer_load_dwordx4 v[100:103], v3, s[32:35], s48 offen offset:768 nt
  buffer_load_dwordx2 v[126:127], v4, s[44:47], s49 offen offset:256
  v_pk_fma_f32 v[164:165], v[164:165], v[142:143], v[142:143] op_sel:[0,0,1] op_sel_hi:[1,0,1]
  v_pk_fma_f32 v[166:167], v[166:167], v[142:143], v[142:143] op_sel:[0,0,1] op_sel_hi:[1,0,1]
  v_pk_fma_f32 v[168:169], v[168:169], v[142:143], v[142:143] op_sel:[0,0,1] op_sel_hi:[1,0,1]
  v_pk_fma_f32 v[170:171], v[170:171], v[142:143], v[142:143] op_sel:[0,0,1] op_sel_hi:[1,0,1]
  v_cvt_pk_bf16_f32 v164, v164, v168
  v_cvt_pk_bf16_f32 v165, v165, v169
  v_cvt_pk_bf16_f32 v166, v166, v170
  v_cvt_pk_bf16_f32 v167, v167, v171
  v_dot2_f32_bf16 v172, v164, v172, 0 neg_hi:[0,1,0]
  v_dot2_f32_bf16 v173, v165, v173, 0 neg_hi:[0,1,0]
  v_dot2_f32_bf16 v174, v166, v174, 0 neg_hi:[0,1,0]
  v_dot2_f32_bf16 v175, v167, v175, 0 neg_hi:[0,1,0]
  v_dot2_f32_bf16 v176, v164, v176, 0
  v_dot2_f32_bf16 v177, v165, v177, 0
  v_dot2_f32_bf16 v178, v166, v178, 0
  v_dot2_f32_bf16 v179, v167, v179, 0
  v_cvt_pk_bf16_f32 v180, v172, v173
  v_cvt_pk_bf16_f32 v181, v174, v175
  v_cvt_pk_bf16_f32 v182, v176, v177
  v_cvt_pk_bf16_f32 v183, v178, v179
  ds_write_b128 v5, v[180:183] offset:272
  s_waitcnt vmcnt(12)
  v_cvt_f32_i32 v164, v104
  v_cvt_f32_i32 v165, v105
  v_cvt_f32_i32 v166, v106
  v_cvt_f32_i32 v167, v107
  v_cvt_f32_i32 v168, v108
  v_cvt_f32_i32 v169, v109
  v_cvt_f32_i32 v170, v110
  v_cvt_f32_i32 v171, v111
  v_perm_b32 v172, v130, v128, s51
  v_perm_b32 v173, v130, v128, s52
  v_perm_b32 v174, v131, v129, s51
  v_perm_b32 v175, v131, v129, s52
  s_cbranch_vccnz L_both2
  v_perm_b32 v176, v128, v130, s51
  v_perm_b32 v177, v128, v130, s52
  v_perm_b32 v178, v129, v131, s51
  v_perm_b32 v179, v129, v131, s52
L_back2:
  buffer_load_dwordx4 v[104:107], v3, s[32:35], s48 offen offset:1024 nt
  buffer_load_dwordx2 v[128:129], v4, s[40:43], s49 offen offset:512
  buffer_load_dwordx4 v[108:111], v3, s[32:35], s48 offen offset:1280 nt
  buffer_load_dwordx2 v[130:131], v4, s[44:47], s49 offen offset:512
  v_pk_fma_f32 v[164:165], v[164:165], v[144:145], v[144:145] op_sel:[0,0,1] op_sel_hi:[1,0,1]
  v_pk_fma_f32 v[166:167], v[166:167], v[144:145], v[144:145] op_sel:[0,0,1] op_sel_hi:[1,0,1]
  v_pk_fma_f32 v[168:169], v[168:169], v[144:145], v[144:145] op_sel:[0,0,1] op_sel_hi:[1,0,1]
  v_pk_fma_f32 v[170:171], v[170:171], v[144:145], v[144:145] op_sel:[0,0,1] op_sel_hi:[1,0,1]
  v_cvt_pk_bf16_f32 v164, v164, v168
  v_cvt_pk_bf16_f32 v165, v165, v169
  v_cvt_pk_bf16_f32 v166, v166, v170
  v_cvt_pk_bf16_f32 v167, v167, v171
  v_dot2_f32_bf16 v172, v164, v172, 0 neg_hi:[0,1,0]
  v_dot2_f32_bf16 v173, v165, v173, 0 neg_hi:[0,1,0]
  v_dot2_f32_bf16 v174, v166, v174, 0 neg_hi:[0,1,0]
  v_dot2_f32_bf16 v175, v167, v175, 0 neg_hi:[0,1,0]
  v_dot2_f32_bf16 v176, v164, v176, 0
  v_dot2_f32_bf16 v177, v165, v177, 0
  v_dot2_f32_bf16 v178, v166, v178, 0
  v_dot2_f32_bf16 v179, v167, v179, 0
  v_cvt_pk_bf16_f32 v180, v172, v173
  v_cvt_pk_bf16_f32 v181, v174, v175
  v_cvt_pk_bf16_f32 v182, v176, v177
  v_cvt_pk_bf16_f32 v183, v178, v179
  ds_write_b128 v5, v[180:183] offset:544
  s_waitcnt vmcnt(12)
  v_cvt_f32_i32 v164, v112
  v_cvt_f32_i32 v165, v113
  v_cvt_f32_i32 v166, v114
  v_cvt_f32_i32 v167, v115
  v_cvt_f32_i32 v168, v116
  v_cvt_f32_i32 v169, v117
  v_cvt_f32_i32 v170, v118
  v_cvt_f32_i32 v171, v119
  v_perm_b32 v172, v134, v132, s51
  v_perm_b32 v173, v134, v132, s52
  v_perm_b32 v174, v135, v133, s51
  v_perm_b32 v175, v135, v133, s52
  s_cbranch_vccnz L_both3
  v_perm_b32 v176, v132, v134, s51
  v_perm_b32 v177, v132, v134, s52
  v_perm_b32 v178, v133, v135, s51
  v_perm_b32 v179, v133, v135, s52
L_back3:
  buffer_load_dwordx4 v[112:115], v3, s[32:35], s48 offen offset:1536 nt
  buffer_load_dwordx2 v[132:133], v4, s[40:43], s49 offen offset:768
  buffer_load_dwordx4 v[116:119], v3, s[32:35], s48 offen offset:1792 nt
  buffer_load_dwordx2 v[134:135], v4, s[44:47], s49 offen offset:768
  v_pk_fma_f32 v[164:165], v[164:165], v[146:147], v[146:147] op_sel:[0,0,1] op_sel_hi:[1,0,1]
  v_pk_fma_f32 v[166:167], v[166:167], v[146:147], v[146:147] op_sel:[0,0,1] op_sel_hi:[1,0,1]
  v_pk_fma_f32 v[168:169], v[168:169], v[146:147], v[146:147] op_sel:[0,0,1] op_sel_hi:[1,0,1]
  v_pk_fma_f32 v[170:171], v[170:171], v[146:147], v[146:147] op_sel:[0,0,1] op_sel_hi:[1,0,1]
  v_cvt_pk_bf16_f32 v164, v164, v168
  v_cvt_pk_bf16_f32 v165, v165, v169
  v_cvt_pk_bf16_f32 v166, v166, v170
  v_cvt_pk_bf16_f32 v167, v167, v171
  v_dot2_f32_bf16 v172, v164, v172, 0 neg_hi:[0,1,0]
  v_dot2_f32_bf16 v173, v165, v173, 0 neg_hi:[0,1,0]
  v_dot2_f32_bf16 v174, v166, v174, 0 neg_hi:[0,1,0]
  v_dot2_f32_bf16 v175, v167, v175, 0 neg_hi:[0,1,0]
  v_dot2_f32_bf16 v176, v164, v176, 0
  v_dot2_f32_bf16 v177, v165, v177, 0
  v_dot2_f32_bf16 v178, v166, v178, 0
  v_dot2_f32_bf16 v179, v167, v179, 0
  v_cvt_pk_bf16_f32 v180, v172, v173
  v_cvt_pk_bf16_f32 v181, v174, v175
  v_cvt_pk_bf16_f32 v182, v176, v177
  v_cvt_pk_bf16_f32 v183, v178, v179
  ds_write_b128 v5, v[180:183] offset:816
  ds_read_b128 v[184:187], v6 offset:0
  ds_read_b128 v[188:191], v6 offset:16
  ds_read_b128 v[192:195], v6 offset:32
  ds_read_b128 v[196:199], v6 offset:48
  ds_read_b128 v[140:143], v7 offset:17408
  ds_read_b128 v[144:147], v7 offset:17424
  v_add_u32 v7, 512, v7
  s_mov_b32 s63, s49
  s_add_u32 s62, s62, 0x20000
  s_and_b32 s62, s62, 0x1fffff
  s_add_u32 s48, s62, s61
  s_lshr_b32 s49, s62, 1
  s_sub_u32 s50, s50, 1
  s_waitcnt lgkmcnt(5)
  v_mfma_f32_16x16x32_bf16 v[200:203], v[184:187], v[148:151], 0
  s_waitcnt lgkmcnt(4)
  v_mfma_f32_16x16x32_bf16 v[200:203], v[188:191], v[152:155], v[200:203]
  s_waitcnt lgkmcnt(3)
  v_mfma_f32_16x16x32_bf16 v[200:203], v[192:195], v[156:159], v[200:203]
  s_waitcnt lgkmcnt(2)
  v_mfma_f32_16x16x32_bf16 v[200:203], v[196:199], v[160:163], v[200:203]
  s_nop 7
  ds_write_b128 v21, v[200:203] offset:37504
  v_max3_f32 v8, v8, v200, v201
  v_max3_f32 v8, v8, v202, v203
  v_add_u32 v21, 512, v21
  s_cmp_gt_u32 s50, s73
  s_cbranch_scc1 L_kloop
  s_cbranch_vccnz L_kgeneral
  s_mov_b32 s70, s48
  s_add_u32 s62, s62, 0x20000
  s_and_b32 s62, s62, 0x1fffff
  s_add_u32 s48, s62, s61
  s_waitcnt vmcnt(12) lgkmcnt(0)
L_walk:
  v_cvt_f32_i32 v164, v88
  v_cvt_f32_i32 v165, v89
  v_cvt_f32_i32 v166, v90
  v_cvt_f32_i32 v167, v91
  v_cvt_f32_i32 v168, v92
  v_cvt_f32_i32 v169, v93
  v_cvt_f32_i32 v170, v94
  v_cvt_f32_i32 v171, v95
  v_perm_b32 v172, v122, v120, s51
  v_perm_b32 v173, v122, v120, s52
  v_perm_b32 v174, v123, v121, s51
  v_perm_b32 v175, v123, v121, s52
  v_perm_b32 v176, v120, v122, s51
  v_perm_b32 v177, v120, v122, s52
  v_perm_b32 v178, v121, v123, s51
  v_perm_b32 v179, v121, v123, s52
  s_cbranch_execz L_hop1
  buffer_load_dwordx4 v[24:27], v3, s[36:39], s70 offen offset:0 nt
  buffer_load_dwordx4 v[32:35], v3, s[36:39], s70 offen offset:512 nt
  buffer_load_dwordx4 v[28:31], v3, s[36:39], s70 offen offset:256 nt
  buffer_load_dwordx4 v[36:39], v3, s[36:39], s70 offen offset:768 nt
L_hop1:
  v_pk_fma_f32 v[164:165], v[164:165], v[140:141], v[140:141] op_sel:[0,0,1] op_sel_hi:[1,0,1]
  v_pk_fma_f32 v[166:167], v[166:167], v[140:141], v[140:141] op_sel:[0,0,1] op_sel_hi:[1,0,1]
  v_pk_fma_f32 v[168:169], v[168:169], v[140:141], v[140:141] op_sel:[0,0,1] op_sel_hi:[1,0,1]
  v_pk_fma_f32 v[170:171], v[170:171], v[140:141], v[140:141] op_sel:[0,0,1] op_sel_hi:[1,0,1]
  v_cvt_pk_bf16_f32 v164, v164, v168
  v_cvt_pk_bf16_f32 v165, v165, v169
  v_cvt_pk_bf16_f32 v166, v166, v170
  v_cvt_pk_bf16_f32 v167, v167, v171
  v_dot2_f32_bf16 v172, v164, v172, 0 neg_hi:[0,1,0]
  v_dot2_f32_bf16 v173, v165, v173, 0 neg_hi:[0,1,0]
  v_dot2_f32_bf16 v174, v166, v174, 0 neg_hi:[0,1,0]
  v_dot2_f32_bf16 v175, v167, v175, 0 neg_hi:[0,1,0]
  v_dot2_f32_bf16 v176, v164, v176, 0
  v_dot2_f32_bf16 v177, v165, v177, 0
  v_dot2_f32_bf16 v178, v166, v178, 0
  v_dot2_f32_bf16 v179, v167, v179, 0
  v_cvt_pk_bf16_f32 v180, v172, v173
  v_cvt_pk_bf16_f32 v181, v174, v175
  v_cvt_pk_bf16_f32 v182, v176, v177
  v_cvt_pk_bf16_f32 v183, v178, v179
  ds_write_b128 v5, v[180:183] offset:0
  s_waitcnt vmcnt(12)
  v_cvt_f32_i32 v164, v96
  v_cvt_f32_i32 v165, v97
  v_cvt_f32_i32 v166, v98
  v_cvt_f32_i32 v167, v99
  v_cvt_f32_i32 v168, v100
  v_cvt_f32_i32 v169, v101
  v_cvt_f32_i32 v170, v102
  v_cvt_f32_i32 v171, v103
  v_perm_b32 v172, v126, v124, s51
  v_perm_b32 v173, v126, v124, s52
  v_perm_b32 v174, v127, v125, s51
  v_perm_b32 v175, v127, v125, s52
  v_perm_b32 v176, v124, v126, s51
  v_perm_b32 v177, v124, v126, s52
  v_perm_b32 v178, v125, v127, s51
  v_perm_b32 v179, v125, v127, s52
  s_cbranch_execz L_hop2
  buffer_load_dwordx4 v[40:43], v3, s[36:39], s70 offen offset:1024 nt
  buffer_load_dwordx4 v[48:51], v3, s[36:39], s70 offen offset:1536 nt
  buffer_load_dwordx4 v[44:47], v3, s[36:39], s70 offen offset:1280 nt
  buffer_load_dwordx4 v[52:55], v3, s[36:39], s70 offen offset:1792 nt
L_hop2:
  v_pk_fma_f32 v[164:165], v[164:165], v[142:143], v[142:143] op_sel:[0,0,1] op_sel_hi:[1,0,1]
  v_pk_fma_f32 v[166:167], v[166:167], v[142:143], v[142:143] op_sel:[0,0,1] op_sel_hi:[1,0,1]
  v_pk_fma_f32 v[168:169], v[168:169], v[142:143], v[142:143] op_sel:[0,0,1] op_sel_hi:[1,0,1]
  v_pk_fma_f32 v[170:171], v[170:171], v[142:143], v[142:143] op_sel:[0,0,1] op_sel_hi:[1,0,1]
  v_cvt_pk_bf16_f32 v164, v164, v168
  v_cvt_pk_bf16_f32 v165, v165, v169
  v_cvt_pk_bf16_f32 v166, v166, v170
  v_cvt_pk_bf16_f32 v167, v167, v171
  v_dot2_f32_bf16 v172, v164, v172, 0 neg_hi:[0,1,0]
  v_dot2_f32_bf16 v173, v165, v173, 0 neg_hi:[0,1,0]
  v_dot2_f32_bf16 v174, v166, v174, 0 neg_hi:[0,1,0]
  v_dot2_f32_bf16 v175, v167, v175, 0 neg_hi:[0,1,0]
  v_dot2_f32_bf16 v176, v164, v176, 0
  v_dot2_f32_bf16 v177, v165, v177, 0
  v_dot2_f32_bf16 v178, v166, v178, 0
  v_dot2_f32_bf16 v179, v167, v179, 0
  v_cvt_pk_bf16_f32 v180, v172, v173
  v_cvt_pk_bf16_f32 v181, v174, v175
  v_cvt_pk_bf16_f32 v182, v176, v177
  v_cvt_pk_bf16_f32 v183, v178, v179
  ds_write_b128 v5, v[180:183] offset:272
  s_waitcnt vmcnt(12)
  v_cvt_f32_i32 v164, v104
  v_cvt_f32_i32 v165, v105
  v_cvt_f32_i32 v166, v106
  v_cvt_f32_i32 v167, v107
  v_cvt_f32_i32 v168, v108
  v_cvt_f32_i32 v169, v109
  v_cvt_f32_i32 v170, v110
  v_cvt_f32_i32 v171, v111
  v_perm_b32 v172, v130, v128, s51
  v_perm_b32 v173, v130, v128, s52
  v_perm_b32 v174, v131, v129, s51
  v_perm_b32 v175, v131, v129, s52
  v_perm_b32 v176, v128, v130, s51
  v_perm_b32 v177, v128, v130, s52
  v_perm_b32 v178, v129, v131, s51
  v_perm_b32 v179, v129, v131, s52
  s_cbranch_execz L_hop3
  buffer_load_dwordx4 v[56:59], v3, s[36:39], s48 offen offset:0 nt
  buffer_load_dwordx4 v[64:67], v3, s[36:39], s48 offen offset:512 nt
  buffer_load_dwordx4 v[60:63], v3, s[36:39], s48 offen offset:256 nt
  buffer_load_dwordx4 v[68:71], v3, s[36:39], s48 offen offset:768 nt
L_hop3:
  v_pk_fma_f32 v[164:165], v[164:165], v[144:145], v[144:145] op_sel:[0,0,1] op_sel_hi:[1,0,1]
  v_pk_fma_f32 v[166:167], v[166:167], v[144:145], v[144:145] op_sel:[0,0,1] op_sel_hi:[1,0,1]
  v_pk_fma_f32 v[168:169], v[168:169], v[144:145], v[144:145] op_sel:[0,0,1] op_sel_hi:[1,0,1]
  v_pk_fma_f32 v[170:171], v[170:171], v[144:145], v[144:145] op_sel:[0,0,1] op_sel_hi:[1,0,1]
  v_cvt_pk_bf16_f32 v164, v164, v168
  v_cvt_pk_bf16_f32 v165, v165, v169
  v_cvt_pk_bf16_f32 v166, v166, v170
  v_cvt_pk_bf16_f32 v167, v167, v171
  v_dot2_f32_bf16 v172, v164, v172, 0 neg_hi:[0,1,0]
  v_dot2_f32_bf16 v173, v165, v173, 0 neg_hi:[0,1,0]
  v_dot2_f32_bf16 v174, v166, v174, 0 neg_hi:[0,1,0]
  v_dot2_f32_bf16 v175, v167, v175, 0 neg_hi:[0,1,0]
  v_dot2_f32_bf16 v176, v164, v176, 0
  v_dot2_f32_bf16 v177, v165, v177, 0
  v_dot2_f32_bf16 v178, v166, v178, 0
  v_dot2_f32_bf16 v179, v167, v179, 0
  v_cvt_pk_bf16_f32 v180, v172, v173
  v_cvt_pk_bf16_f32 v181, v174, v175
  v_cvt_pk_bf16_f32 v182, v176, v177
  v_cvt_pk_bf16_f32 v183, v178, v179
  ds_write_b128 v5, v[180:183] offset:544
  s_waitcnt vmcnt(12)
  v_cvt_f32_i32 v164, v112
  v_cvt_f32_i32 v165, v113
  v_cvt_f32_i32 v166, v114
  v_cvt_f32_i32 v167, v115
  v_cvt_f32_i32 v168, v116
  v_cvt_f32_i32 v169, v117
  v_cvt_f32_i32 v170, v118
  v_cvt_f32_i32 v171, v119
  v_perm_b32 v172, v134, v132, s51
  v_perm_b32 v173, v134, v132, s52
  v_perm_b32 v174, v135, v133, s51
  v_perm_b32 v175, v135, v133, s52
  v_perm_b32 v176, v132, v134, s51
  v_perm_b32 v177, v132, v134, s52
  v_perm_b32 v178, v133, v135, s51
  v_perm_b32 v179, v133, v135, s52
  s_cbranch_execz L_hop4
  buffer_load_dwordx4 v[72:75], v3, s[36:39], s48 offen offset:1024 nt
  buffer_load_dwordx4 v[80:83], v3, s[36:39], s48 offen offset:1536 nt
  buffer_load_dwordx4 v[76:79], v3, s[36:39], s48 offen offset:1280 nt
  buffer_load_dwordx4 v[84:87], v3, s[36:39], s48 offen offset:1792 nt
L_hop4:
  v_pk_fma_f32 v[164:165], v[164:165], v[146:147], v[146:147] op_sel:[0,0,1] op_sel_hi:[1,0,1]
  v_pk_fma_f32 v[166:167], v[166:167], v[146:147], v[146:147] op_sel:[0,0,1] op_sel_hi:[1,0,1]
  v_pk_fma_f32 v[168:169], v[168:169], v[146:147], v[146:147] op_sel:[0,0,1] op_sel_hi:[1,0,1]
  v_pk_fma_f32 v[170:171], v[170:171], v[146:147], v[146:147] op_sel:[0,0,1] op_sel_hi:[1,0,1]
  v_cvt_pk_bf16_f32 v164, v164, v168
  v_cvt_pk_bf16_f32 v165, v165, v169
  v_cvt_pk_bf16_f32 v166, v166, v170
  v_cvt_pk_bf16_f32 v167, v167, v171
  v_dot2_f32_bf16 v172, v164, v172, 0 neg_hi:[0,1,0]
  v_dot2_f32_bf16 v173, v165, v173, 0 neg_hi:[0,1,0]
  v_dot2_f32_bf16 v174, v166, v174, 0 neg_hi:[0,1,0]
  v_dot2_f32_bf16 v175, v167, v175, 0 neg_hi:[0,1,0]
  v_dot2_f32_bf16 v176, v164, v176, 0
  v_dot2_f32_bf16 v177, v165, v177, 0
  v_dot2_f32_bf16 v178, v166, v178, 0
  v_dot2_f32_bf16 v179, v167, v179, 0
  v_cvt_pk_bf16_f32 v180, v172, v173
  v_cvt_pk_bf16_f32 v181, v174, v175
  v_cvt_pk_bf16_f32 v182, v176, v177
  v_cvt_pk_bf16_f32 v183, v178, v179
  ds_write_b128 v5, v[180:183] offset:816
  ds_read_b128 v[184:187], v6 offset:0
  ds_read_b128 v[188:191], v6 offset:16
  ds_read_b128 v[192:195], v6 offset:32
  ds_read_b128 v[196:199], v6 offset:48
  s_waitcnt lgkmcnt(3)
  v_mfma_f32_16x16x32_bf16 v[200:203], v[184:187], v[148:151], 0
  s_waitcnt lgkmcnt(2)
  v_mfma_f32_16x16x32_bf16 v[200:203], v[188:191], v[152:155], v[200:203]
  s_waitcnt lgkmcnt(1)
  v_mfma_f32_16x16x32_bf16 v[200:203], v[192:195], v[156:159], v[200:203]
  s_waitcnt lgkmcnt(0)
  v_mfma_f32_16x16x32_bf16 v[200:203], v[196:199], v[160:163], v[200:203]
  s_nop 7
  ds_write_b128 v21, v[200:203] offset:37504
  v_max3_f32 v8, v8, v200, v201
  v_max3_f32 v8, v8, v202, v203
  v_add_u32 v21, 512, v21
L_kdone:
  v_mov_b32 v14, v8
  v_subrev_u32 v21, 8192, v21
  v_subrev_u32 v7, 8192, v7
  v_permlane32_swap_b32 v8, v14
  v_max_f32 v8, v8, v14
  v_mov_b32 v14, v8
  ds_read_b128 v[184:187], v21 offset:37504
  ds_read_b128 v[188:191], v21 offset:38016
  ds_read_b128 v[168:171], v7 offset:26112
  ds_read_b128 v[172:175], v7 offset:26128
  ds_read_b128 v[176:179], v7 offset:26624
  ds_read_b128 v[180:183], v7 offset:26640
  v_add_u32 v21, 1024, v21
  v_add_u32 v7, 1024, v7
  v_permlane16_swap_b32 v8, v14
  v_max_f32 v8, v8, v14
  v_mul_f32 v8, s53, v8
  v_mov_b32 v88, 0
  v_mov_b32 v89, 0
  v_mov_b32 v90, 0
  v_mov_b32 v91, 0
  v_mov_b32 v92, 0
  v_mov_b32 v93, 0
  v_mov_b32 v94, 0
  v_mov_b32 v95, 0
  v_mov_b32 v96, 0
  v_mov_b32 v97, 0
  v_mov_b32 v98, 0
  v_mov_b32 v99, 0
  v_mov_b32 v100, 0
  v_mov_b32 v101, 0
  v_mov_b32 v102, 0
  v_mov_b32 v103, 0
  v_mov_b32 v104, 0
  v_mov_b32 v105, 0
  v_mov_b32 v106, 0
  v_mov_b32 v107, 0
  v_mov_b32 v108, 0
  v_mov_b32 v109, 0
  v_mov_b32 v110, 0
  v_mov_b32 v111, 0
  v_mov_b32 v112, 0
  v_mov_b32 v113, 0
  v_mov_b32 v114, 0
  v_mov_b32 v115, 0
  v_mov_b32 v116, 0
  v_mov_b32 v117, 0
  v_mov_b32 v118, 0
  v_mov_b32 v119, 0
  v_mov_b32 v9, 0
  s_mov_b32 s50, 6
L_vloop:
  s_add_u32 s62, s62, 0x20000
  s_and_b32 s62, s62, 0x1fffff
  s_add_u32 s48, s62, s61
  s_add_u32 s62, s62, 0x20000
  s_and_b32 s62, s62, 0x1fffff
  s_add_u32 s70, s62, s61
  s_waitcnt vmcnt(14) lgkmcnt(0)
  v_cvt_f32_i32 v152, v24
  v_cvt_f32_i32 v153, v25
  v_cvt_f32_i32 v154, v26
  v_cvt_f32_i32 v155, v27
  v_cvt_f32_i32 v156, v32
  v_cvt_f32_i32 v157, v33
  v_cvt_f32_i32 v158, v34
  v_cvt_f32_i32 v159, v35
  s_cbranch_execz L_hop5
  s_waitcnt vmcnt(5)
  buffer_load_dwordx4 v[24:27], v3, s[36:39], s48 offen offset:0 nt
  s_waitcnt vmcnt(5)
  buffer_load_dwordx4 v[32:35], v3, s[36:39], s48 offen offset:512 nt
L_hop5:
  v_pk_fma_f32 v[152:153], v[152:153], v[168:169], v[168:169] op_sel:[0,0,1] op_sel_hi:[1,0,1]
  v_pk_fma_f32 v[154:155], v[154:155], v[168:169], v[168:169] op_sel:[0,0,1] op_sel_hi:[1,0,1]
  v_pk_fma_f32 v[156:157], v[156:157], v[170:171], v[170:171] op_sel:[0,0,1] op_sel_hi:[1,0,1]
  v_pk_fma_f32 v[158:159], v[158:159], v[170:171], v[170:171] op_sel:[0,0,1] op_sel_hi:[1,0,1]
  v_cvt_pk_bf16_f32 v120, v152, v156
  v_cvt_pk_bf16_f32 v124, v153, v157
  v_cvt_pk_bf16_f32 v128, v154, v158
  v_cvt_pk_bf16_f32 v132, v155, v159
  v_fma_f32 v184, v184, s53, -v8
  v_fma_f32 v185, v185, s53, -v8
  v_fma_f32 v186, v186, s53, -v8
  v_fma_f32 v187, v187, s53, -v8
  v_fma_f32 v188, v188, s53, -v8
  v_fma_f32 v189, v189, s53, -v8
  v_fma_f32 v190, v190, s53, -v8
  v_fma_f32 v191, v191, s53, -v8
  v_exp_f32 v184, v184
  v_exp_f32 v185, v185
  v_exp_f32 v186, v186
  v_exp_f32 v187, v187
  v_exp_f32 v188, v188
  v_exp_f32 v189, v189
  v_exp_f32 v190, v190
  v_exp_f32 v191, v191
  s_waitcnt vmcnt(14)
  v_cvt_f32_i32 v152, v28
  v_cvt_f32_i32 v153, v29
  v_cvt_f32_i32 v154, v30
  v_cvt_f32_i32 v155, v31
  v_cvt_f32_i32 v156, v36
  v_cvt_f32_i32 v157, v37
  v_cvt_f32_i32 v158, v38
  v_cvt_f32_i32 v159, v39
  s_cbranch_execz L_hop6
  s_waitcnt vmcnt(5)
  buffer_load_dwordx4 v[28:31], v3, s[36:39], s48 offen offset:256 nt
  s_waitcnt vmcnt(5)
  buffer_load_dwordx4 v[36:39], v3, s[36:39], s48 offen offset:768 nt
L_hop6:
  v_pk_fma_f32 v[152:153], v[152:153], v[168:169], v[168:169] op_sel:[0,0,1] op_sel_hi:[1,0,1]
  v_pk_fma_f32 v[154:155], v[154:155], v[168:169], v[168:169] op_sel:[0,0,1] op_sel_hi:[1,0,1]
  v_pk_fma_f32 v[156:157], v[156:157], v[170:171], v[170:171] op_sel:[0,0,1] op_sel_hi:[1,0,1]
  v_pk_fma_f32 v[158:159], v[158:159], v[170:171], v[170:171] op_sel:[0,0,1] op_sel_hi:[1,0,1]
  v_cvt_pk_bf16_f32 v136, v152, v156
  v_cvt_pk_bf16_f32 v140, v153, v157
  v_cvt_pk_bf16_f32 v144, v154, v158
  v_cvt_pk_bf16_f32 v148, v155, v159
  v_cvt_pk_bf16_f32 v192, v184, v185
  v_cvt_pk_bf16_f32 v193, v186, v187
  v_cvt_pk_bf16_f32 v194, v188, v189
  v_cvt_pk_bf16_f32 v195, v190, v191
  v_pk_add_f32 v[184:185], v[184:185], v[186:187]
  v_pk_add_f32 v[188:189], v[188:189], v[190:191]
  v_pk_add_f32 v[184:185], v[184:185], v[188:189]
  v_add_f32 v9, v9, v184
  v_add_f32 v9, v9, v185
  s_waitcnt vmcnt(14)
  v_cvt_f32_i32 v152, v40
  v_cvt_f32_i32 v153, v41
  v_cvt_f32_i32 v154, v42
  v_cvt_f32_i32 v155, v43
  v_cvt_f32_i32 v156, v48
  v_cvt_f32_i32 v157, v49
  v_cvt_f32_i32 v158, v50
  v_cvt_f32_i32 v159, v51
  s_cbranch_execz L_hop7
  s_waitcnt vmcnt(5)
  buffer_load_dwordx4 v[40:43], v3, s[36:39], s48 offen offset:1024 nt
  s_waitcnt vmcnt(5)
  buffer_load_dwordx4 v[48:51], v3, s[36:39], s48 offen offset:1536 nt
L_hop7:
  v_pk_fma_f32 v[152:153], v[152:153], v[172:173], v[172:173] op_sel:[0,0,1] op_sel_hi:[1,0,1]
  v_pk_fma_f32 v[154:155], v[154:155], v[172:173], v[172:173] op_sel:[0,0,1] op_sel_hi:[1,0,1]
  v_pk_fma_f32 v[156:157], v[156:157], v[174:175], v[174:175] op_sel:[0,0,1] op_sel_hi:[1,0,1]
  v_pk_fma_f32 v[158:159], v[158:159], v[174:175], v[174:175] op_sel:[0,0,1] op_sel_hi:[1,0,1]
  v_cvt_pk_bf16_f32 v121, v152, v156
  v_cvt_pk_bf16_f32 v125, v153, v157
  v_cvt_pk_bf16_f32 v129, v154, v158
  v_cvt_pk_bf16_f32 v133, v155, v159
  s_waitcnt vmcnt(14)
  v_cvt_f32_i32 v152, v44
  v_cvt_f32_i32 v153, v45
  v_cvt_f32_i32 v154, v46
  v_cvt_f32_i32 v155, v47
  v_cvt_f32_i32 v156, v52
  v_cvt_f32_i32 v157, v53
  v_cvt_f32_i32 v158, v54
  v_cvt_f32_i32 v159, v55
  s_cbranch_execz L_hop8
  s_waitcnt vmcnt(5)
  buffer_load_dwordx4 v[44:47], v3, s[36:39], s48 offen offset:1280 nt
  s_waitcnt vmcnt(5)
  buffer_load_dwordx4 v[52:55], v3, s[36:39], s48 offen offset:1792 nt
L_hop8:
  v_pk_fma_f32 v[152:153], v[152:153], v[172:173], v[172:173] op_sel:[0,0,1] op_sel_hi:[1,0,1]
  v_pk_fma_f32 v[154:155], v[154:155], v[172:173], v[172:173] op_sel:[0,0,1] op_sel_hi:[1,0,1]
  v_pk_fma_f32 v[156:157], v[156:157], v[174:175], v[174:175] op_sel:[0,0,1] op_sel_hi:[1,0,1]
  v_pk_fma_f32 v[158:159], v[158:159], v[174:175], v[174:175] op_sel:[0,0,1] op_sel_hi:[1,0,1]
  v_cvt_pk_bf16_f32 v137, v152, v156
  v_cvt_pk_bf16_f32 v141, v153, v157
  v_cvt_pk_bf16_f32 v145, v154, v158
  v_cvt_pk_bf16_f32 v149, v155, v159
  s_waitcnt vmcnt(14)
  v_cvt_f32_i32 v152, v56
  v_cvt_f32_i32 v153, v57
  v_cvt_f32_i32 v154, v58
  v_cvt_f32_i32 v155, v59
  v_cvt_f32_i32 v156, v64
  v_cvt_f32_i32 v157, v65
  v_cvt_f32_i32 v158, v66
  v_cvt_f32_i32 v159, v67
  s_cbranch_execz L_hop9
  s_waitcnt vmcnt(5)
  buffer_load_dwordx4 v[56:59], v3, s[36:39], s70 offen offset:0 nt
  s_waitcnt vmcnt(5)
  buffer_load_dwordx4 v[64:67], v3, s[36:39], s70 offen offset:512 nt
L_hop9:
  v_pk_fma_f32 v[152:153], v[152:153], v[176:177], v[176:177] op_sel:[0,0,1] op_sel_hi:[1,0,1]
  v_pk_fma_f32 v[154:155], v[154:155], v[176:177], v[176:177] op_sel:[0,0,1] op_sel_hi:[1,0,1]
  v_pk_fma_f32 v[156:157], v[156:157], v[178:179], v[178:179] op_sel:[0,0,1] op_sel_hi:[1,0,1]
  v_pk_fma_f32 v[158:159], v[158:159], v[178:179], v[178:179] op_sel:[0,0,1] op_sel_hi:[1,0,1]
  v_cvt_pk_bf16_f32 v122, v152, v156
  v_cvt_pk_bf16_f32 v126, v153, v157
  v_cvt_pk_bf16_f32 v130, v154, v158
  v_cvt_pk_bf16_f32 v134, v155, v159
  s_waitcnt vmcnt(14)
  v_cvt_f32_i32 v152, v60
  v_cvt_f32_i32 v153, v61
  v_cvt_f32_i32 v154, v62
  v_cvt_f32_i32 v155, v63
  v_cvt_f32_i32 v156, v68
  v_cvt_f32_i32 v157, v69
  v_cvt_f32_i32 v158, v70
  v_cvt_f32_i32 v159, v71
  s_cbranch_execz L_hop10
  s_waitcnt vmcnt(5)
  buffer_load_dwordx4 v[60:63], v3, s[36:39], s70 offen offset:256 nt
  s_waitcnt vmcnt(5)
  buffer_load_dwordx4 v[68:71], v3, s[36:39], s70 offen offset:768 nt
L_hop10:
  v_pk_fma_f32 v[152:153], v[152:153], v[176:177], v[176:177] op_sel:[0,0,1] op_sel_hi:[1,0,1]
  v_pk_fma_f32 v[154:155], v[154:155], v[176:177], v[176:177] op_sel:[0,0,1] op_sel_hi:[1,0,1]
  v_pk_fma_f32 v[156:157], v[156:157], v[178:179], v[178:179] op_sel:[0,0,1] op_sel_hi:[1,0,1]
  v_pk_fma_f32 v[158:159], v[158:159], v[178:179], v[178:179] op_sel:[0,0,1] op_sel_hi:[1,0,1]
  v_cvt_pk_bf16_f32 v138, v152, v156
  v_cvt_pk_bf16_f32 v142, v153, v157
  v_cvt_pk_bf16_f32 v146, v154, v158
  v_cvt_pk_bf16_f32 v150, v155, v159
  s_waitcnt vmcnt(14)
  v_cvt_f32_i32 v152, v72
  v_cvt_f32_i32 v153, v73
  v_cvt_f32_i32 v154, v74
  v_cvt_f32_i32 v155, v75
  v_cvt_f32_i32 v156, v80
  v_cvt_f32_i32 v157, v81
  v_cvt_f32_i32 v158, v82
  v_cvt_f32_i32 v159, v83
  s_cbranch_execz L_hop11
  s_waitcnt vmcnt(5)
  buffer_load_dwordx4 v[72:75], v3, s[36:39], s70 offen offset:1024 nt
  s_waitcnt vmcnt(5)
  buffer_load_dwordx4 v[80:83], v3, s[36:39], s70 offen offset:1536 nt
L_hop11:
  v_pk_fma_f32 v[152:153], v[152:153], v[180:181], v[180:181] op_sel:[0,0,1] op_sel_hi:[1,0,1]
  v_pk_fma_f32 v[154:155], v[154:155], v[180:181], v[180:181] op_sel:[0,0,1] op_sel_hi:[1,0,1]
  v_pk_fma_f32 v[156:157], v[156:157], v[182:183], v[182:183] op_sel:[0,0,1] op_sel_hi:[1,0,1]
  v_pk_fma_f32 v[158:159], v[158:159], v[182:183], v[182:183] op_sel:[0,0,1] op_sel_hi:[1,0,1]
  v_cvt_pk_bf16_f32 v123, v152, v156
  v_cvt_pk_bf16_f32 v127, v153, v157
  v_cvt_pk_bf16_f32 v131, v154, v158
  v_cvt_pk_bf16_f32 v135, v155, v159
  s_waitcnt vmcnt(14)
  v_cvt_f32_i32 v152, v76
  v_cvt_f32_i32 v153, v77
  v_cvt_f32_i32 v154, v78
  v_cvt_f32_i32 v155, v79
  v_cvt_f32_i32 v156, v84
  v_cvt_f32_i32 v157, v85
  v_cvt_f32_i32 v158, v86
  v_cvt_f32_i32 v159, v87
  s_cbranch_execz L_hop12
  s_waitcnt vmcnt(5)
  buffer_load_dwordx4 v[76:79], v3, s[36:39], s70 offen offset:1280 nt
  s_waitcnt vmcnt(5)
  buffer_load_dwordx4 v[84:87], v3, s[36:39], s70 offen offset:1792 nt
L_hop12:
  v_pk_fma_f32 v[152:153], v[152:153], v[180:181], v[180:181] op_sel:[0,0,1] op_sel_hi:[1,0,1]
  v_pk_fma_f32 v[154:155], v[154:155], v[180:181], v[180:181] op_sel:[0,0,1] op_sel_hi:[1,0,1]
  v_pk_fma_f32 v[156:157], v[156:157], v[182:183], v[182:183] op_sel:[0,0,1] op_sel_hi:[1,0,1]
  v_pk_fma_f32 v[158:159], v[158:159], v[182:183], v[182:183] op_sel:[0,0,1] op_sel_hi:[1,0,1]
  v_cvt_pk_bf16_f32 v139, v152, v156
  v_cvt_pk_bf16_f32 v143, v153, v157
  v_cvt_pk_bf16_f32 v147, v154, v158
  v_cvt_pk_bf16_f32 v151, v155, v159
  ds_read_b128 v[184:187], v21 offset:37504
  ds_read_b128 v[188:191], v21 offset:38016
  ds_read_b128 v[168:171], v7 offset:26112
  ds_read_b128 v[172:175], v7 offset:26128
  ds_read_b128 v[176:179], v7 offset:26624
  ds_read_b128 v[180:183], v7 offset:26640
  v_add_u32 v21, 1024, v21
  v_add_u32 v7, 1024, v7
  v_mfma_f32_16x16x32_bf16 v[88:91], v[120:123], v[192:195], v[88:91]
  v_mfma_f32_16x16x32_bf16 v[92:95], v[124:127], v[192:195], v[92:95]
  v_mfma_f32_16x16x32_bf16 v[96:99], v[128:131], v[192:195], v[96:99]
  v_mfma_f32_16x16x32_bf16 v[100:103], v[132:135], v[192:195], v[100:103]
  v_mfma_f32_16x16x32_bf16 v[104:107], v[136:139], v[192:195], v[104:107]
  v_mfma_f32_16x16x32_bf16 v[108:111], v[140:143], v[192:195], v[108:111]
  v_mfma_f32_16x16x32_bf16 v[112:115], v[144:147], v[192:195], v[112:115]
  v_mfma_f32_16x16x32_bf16 v[116:119], v[148:151], v[192:195], v[116:119]
  s_sub_u32 s50, s50, 1
  s_cmp_lg_u32 s50, 0
  s_cbranch_execz L_vopen
  s_cbranch_scc1 L_vloop
L_vopen:
  s_add_u32 s62, s62, 0x20000
  s_and_b32 s62, s62, 0x1fffff
  s_add_u32 s48, s62, s61
  s_add_u32 s62, s62, 0x20000
  s_and_b32 s62, s62, 0x1fffff
  s_add_u32 s70, s62, s61
  s_waitcnt vmcnt(14) lgkmcnt(0)
  s_cbranch_execz L_hop13
  s_load_dword s72, s[28:29], 252
L_hop13:
  v_cvt_f32_i32 v152, v24
  v_cvt_f32_i32 v153, v25
  v_cvt_f32_i32 v154, v26
  v_cvt_f32_i32 v155, v27
  v_cvt_f32_i32 v156, v32
  v_cvt_f32_i32 v157, v33
  v_cvt_f32_i32 v158, v34
  v_cvt_f32_i32 v159, v35
  s_cbranch_execz L_hop14
  buffer_load_dwordx4 v[24:27], v3, s[36:39], s48 offen offset:0 nt
  buffer_load_dwordx4 v[32:35], v3, s[36:39], s48 offen offset:512 nt
L_hop14:
  v_pk_fma_f32 v[152:153], v[152:153], v[168:169], v[168:169] op_sel:[0,0,1] op_sel_hi:[1,0,1]
  v_pk_fma_f32 v[154:155], v[154:155], v[168:169], v[168:169] op_sel:[0,0,1] op_sel_hi:[1,0,1]
  v_pk_fma_f32 v[156:157], v[156:157], v[170:171], v[170:171] op_sel:[0,0,1] op_sel_hi:[1,0,1]
  v_pk_fma_f32 v[158:159], v[158:159], v[170:171], v[170:171] op_sel:[0,0,1] op_sel_hi:[1,0,1]
  v_cvt_pk_bf16_f32 v120, v152, v156
  v_cvt_pk_bf16_f32 v124, v153, v157
  v_cvt_pk_bf16_f32 v128, v154, v158
  v_cvt_pk_bf16_f32 v132, v155, v159
  v_fma_f32 v184, v184, s53, -v8
  v_fma_f32 v185, v185, s53, -v8
  v_fma_f32 v186, v186, s53, -v8
  v_fma_f32 v187, v187, s53, -v8
  v_fma_f32 v188, v188, s53, -v8
  v_fma_f32 v189, v189, s53, -v8
  v_fma_f32 v190, v190, s53, -v8
  v_fma_f32 v191, v191, s53, -v8
  v_exp_f32 v184, v184
  v_exp_f32 v185, v185
  v_exp_f32 v186, v186
  v_exp_f32 v187, v187
  v_exp_f32 v188, v188
  v_exp_f32 v189, v189
  v_exp_f32 v190, v190
  v_exp_f32 v191, v191
  s_waitcnt vmcnt(14)
  v_cvt_f32_i32 v152, v28
  v_cvt_f32_i32 v153, v29
  v_cvt_f32_i32 v154, v30
  v_cvt_f32_i32 v155, v31
  v_cvt_f32_i32 v156, v36
  v_cvt_f32_i32 v157, v37
  v_cvt_f32_i32 v158, v38
  v_cvt_f32_i32 v159, v39
  s_cbranch_execz L_hop15
  buffer_load_dwordx4 v[28:31], v3, s[36:39], s48 offen offset:256 nt
  buffer_load_dwordx4 v[36:39], v3, s[36:39], s48 offen offset:768 nt
L_hop15:
  v_pk_fma_f32 v[152:153], v[152:153], v[168:169], v[168:169] op_sel:[0,0,1] op_sel_hi:[1,0,1]
  v_pk_fma_f32 v[154:155], v[154:155], v[168:169], v[168:169] op_sel:[0,0,1] op_sel_hi:[1,0,1]
  v_pk_fma_f32 v[156:157], v[156:157], v[170:171], v[170:171] op_sel:[0,0,1] op_sel_hi:[1,0,1]
  v_pk_fma_f32 v[158:159], v[158:159], v[170:171], v[170:171] op_sel:[0,0,1] op_sel_hi:[1,0,1]
  v_cvt_pk_bf16_f32 v136, v152, v156
  v_cvt_pk_bf16_f32 v140, v153, v157
  v_cvt_pk_bf16_f32 v144, v154, v158
  v_cvt_pk_bf16_f32 v148, v155, v159
  v_cvt_pk_bf16_f32 v192, v184, v185
  v_cvt_pk_bf16_f32 v193, v186, v187
  v_cvt_pk_bf16_f32 v194, v188, v189
  v_cvt_pk_bf16_f32 v195, v190, v191
  v_pk_add_f32 v[184:185], v[184:185], v[186:187]
  v_pk_add_f32 v[188:189], v[188:189], v[190:191]
  v_pk_add_f32 v[184:185], v[184:185], v[188:189]
  v_add_f32 v9, v9, v184
  v_add_f32 v9, v9, v185
  s_waitcnt vmcnt(14)
  v_cvt_f32_i32 v152, v40
  v_cvt_f32_i32 v153, v41
  v_cvt_f32_i32 v154, v42
  v_cvt_f32_i32 v155, v43
  v_cvt_f32_i32 v156, v48
  v_cvt_f32_i32 v157, v49
  v_cvt_f32_i32 v158, v50
  v_cvt_f32_i32 v159, v51
  s_cbranch_execz L_hop16
  buffer_load_dwordx4 v[40:43], v3, s[36:39], s48 offen offset:1024 nt
  buffer_load_dwordx4 v[48:51], v3, s[36:39], s48 offen offset:1536 nt
L_hop16:
  v_pk_fma_f32 v[152:153], v[152:153], v[172:173], v[172:173] op_sel:[0,0,1] op_sel_hi:[1,0,1]
  v_pk_fma_f32 v[154:155], v[154:155], v[172:173], v[172:173] op_sel:[0,0,1] op_sel_hi:[1,0,1]
  v_pk_fma_f32 v[156:157], v[156:157], v[174:175], v[174:175] op_sel:[0,0,1] op_sel_hi:[1,0,1]
  v_pk_fma_f32 v[158:159], v[158:159], v[174:175], v[174:175] op_sel:[0,0,1] op_sel_hi:[1,0,1]
  v_cvt_pk_bf16_f32 v121, v152, v156
  v_cvt_pk_bf16_f32 v125, v153, v157
  v_cvt_pk_bf16_f32 v129, v154, v158
  v_cvt_pk_bf16_f32 v133, v155, v159
  s_waitcnt vmcnt(14)
  v_cvt_f32_i32 v152, v44
  v_cvt_f32_i32 v153, v45
  v_cvt_f32_i32 v154, v46
  v_cvt_f32_i32 v155, v47
  v_cvt_f32_i32 v156, v52
  v_cvt_f32_i32 v157, v53
  v_cvt_f32_i32 v158, v54
  v_cvt_f32_i32 v159, v55
  s_cbranch_execz L_hop17
  buffer_load_dwordx4 v[44:47], v3, s[36:39], s48 offen offset:1280 nt
  buffer_load_dwordx4 v[52:55], v3, s[36:39], s48 offen offset:1792 nt
L_hop17:
  v_pk_fma_f32 v[152:153], v[152:153], v[172:173], v[172:173] op_sel:[0,0,1] op_sel_hi:[1,0,1]
  v_pk_fma_f32 v[154:155], v[154:155], v[172:173], v[172:173] op_sel:[0,0,1] op_sel_hi:[1,0,1]
  v_pk_fma_f32 v[156:157], v[156:157], v[174:175], v[174:175] op_sel:[0,0,1] op_sel_hi:[1,0,1]
  v_pk_fma_f32 v[158:159], v[158:159], v[174:175], v[174:175] op_sel:[0,0,1] op_sel_hi:[1,0,1]
  v_cvt_pk_bf16_f32 v137, v152, v156
  v_cvt_pk_bf16_f32 v141, v153, v157
  v_cvt_pk_bf16_f32 v145, v154, v158
  v_cvt_pk_bf16_f32 v149, v155, v159
  s_waitcnt vmcnt(14)
  v_cvt_f32_i32 v152, v56
  v_cvt_f32_i32 v153, v57
  v_cvt_f32_i32 v154, v58
  v_cvt_f32_i32 v155, v59
  v_cvt_f32_i32 v156, v64
  v_cvt_f32_i32 v157, v65
  v_cvt_f32_i32 v158, v66
  v_cvt_f32_i32 v159, v67
  s_cbranch_execz L_hop18
  buffer_load_dwordx4 v[56:59], v3, s[36:39], s70 offen offset:0 nt
  buffer_load_dwordx4 v[64:67], v3, s[36:39], s70 offen offset:512 nt
L_hop18:
  v_pk_fma_f32 v[152:153], v[152:153], v[176:177], v[176:177] op_sel:[0,0,1] op_sel_hi:[1,0,1]
  v_pk_fma_f32 v[154:155], v[154:155], v[176:177], v[176:177] op_sel:[0,0,1] op_sel_hi:[1,0,1]
  v_pk_fma_f32 v[156:157], v[156:157], v[178:179], v[178:179] op_sel:[0,0,1] op_sel_hi:[1,0,1]
  v_pk_fma_f32 v[158:159], v[158:159], v[178:179], v[178:179] op_sel:[0,0,1] op_sel_hi:[1,0,1]
  v_cvt_pk_bf16_f32 v122, v152, v156
  v_cvt_pk_bf16_f32 v126, v153, v157
  v_cvt_pk_bf16_f32 v130, v154, v158
  v_cvt_pk_bf16_f32 v134, v155, v159
  s_waitcnt vmcnt(14)
  v_cvt_f32_i32 v152, v60
  v_cvt_f32_i32 v153, v61
  v_cvt_f32_i32 v154, v62
  v_cvt_f32_i32 v155, v63
  v_cvt_f32_i32 v156, v68
  v_cvt_f32_i32 v157, v69
  v_cvt_f32_i32 v158, v70
  v_cvt_f32_i32 v159, v71
  s_cbranch_execz L_hop19
  buffer_load_dwordx4 v[60:63], v3, s[36:39], s70 offen offset:256 nt
  buffer_load_dwordx4 v[68:71], v3, s[36:39], s70 offen offset:768 nt
L_hop19:
  v_pk_fma_f32 v[152:153], v[152:153], v[176:177], v[176:177] op_sel:[0,0,1] op_sel_hi:[1,0,1]
  v_pk_fma_f32 v[154:155], v[154:155], v[176:177], v[176:177] op_sel:[0,0,1] op_sel_hi:[1,0,1]
  v_pk_fma_f32 v[156:157], v[156:157], v[178:179], v[178:179] op_sel:[0,0,1] op_sel_hi:[1,0,1]
  v_pk_fma_f32 v[158:159], v[158:159], v[178:179], v[178:179] op_sel:[0,0,1] op_sel_hi:[1,0,1]
  v_cvt_pk_bf16_f32 v138, v152, v156
  v_cvt_pk_bf16_f32 v142, v153, v157
  v_cvt_pk_bf16_f32 v146, v154, v158
  v_cvt_pk_bf16_f32 v150, v155, v159
  s_waitcnt vmcnt(14)
  v_cvt_f32_i32 v152, v72
  v_cvt_f32_i32 v153, v73
  v_cvt_f32_i32 v154, v74
  v_cvt_f32_i32 v155, v75
  v_cvt_f32_i32 v156, v80
  v_cvt_f32_i32 v157, v81
  v_cvt_f32_i32 v158, v82
  v_cvt_f32_i32 v159, v83
  s_cbranch_execz L_hop20
  buffer_load_dwordx4 v[72:75], v3, s[36:39], s70 offen offset:1024 nt
  buffer_load_dwordx4 v[80:83], v3, s[36:39], s70 offen offset:1536 nt
L_hop20:
  v_pk_fma_f32 v[152:153], v[152:153], v[180:181], v[180:181] op_sel:[0,0,1] op_sel_hi:[1,0,1]
  v_pk_fma_f32 v[154:155], v[154:155], v[180:181], v[180:181] op_sel:[0,0,1] op_sel_hi:[1,0,1]
  v_pk_fma_f32 v[156:157], v[156:157], v[182:183], v[182:183] op_sel:[0,0,1] op_sel_hi:[1,0,1]
  v_pk_fma_f32 v[158:159], v[158:159], v[182:183], v[182:183] op_sel:[0,0,1] op_sel_hi:[1,0,1]
  v_cvt_pk_bf16_f32 v123, v152, v156
  v_cvt_pk_bf16_f32 v127, v153, v157
  v_cvt_pk_bf16_f32 v131, v154, v158
  v_cvt_pk_bf16_f32 v135, v155, v159
  s_waitcnt vmcnt(14)
  v_cvt_f32_i32 v152, v76
  v_cvt_f32_i32 v153, v77
  v_cvt_f32_i32 v154, v78
  v_cvt_f32_i32 v155, v79
  v_cvt_f32_i32 v156, v84
  v_cvt_f32_i32 v157, v85
  v_cvt_f32_i32 v158, v86
  v_cvt_f32_i32 v159, v87
  s_cbranch_execz L_hop21
  buffer_load_dwordx4 v[76:79], v3, s[36:39], s70 offen offset:1280 nt
  buffer_load_dwordx4 v[84:87], v3, s[36:39], s70 offen offset:1792 nt
L_hop21:
  v_pk_fma_f32 v[152:153], v[152:153], v[180:181], v[180:181] op_sel:[0,0,1] op_sel_hi:[1,0,1]
  v_pk_fma_f32 v[154:155], v[154:155], v[180:181], v[180:181] op_sel:[0,0,1] op_sel_hi:[1,0,1]
  v_pk_fma_f32 v[156:157], v[156:157], v[182:183], v[182:183] op_sel:[0,0,1] op_sel_hi:[1,0,1]
  v_pk_fma_f32 v[158:159], v[158:159], v[182:183], v[182:183] op_sel:[0,0,1] op_sel_hi:[1,0,1]
  v_cvt_pk_bf16_f32 v139, v152, v156
  v_cvt_pk_bf16_f32 v143, v153, v157
  v_cvt_pk_bf16_f32 v147, v154, v158
  v_cvt_pk_bf16_f32 v151, v155, v159
  ds_read_b128 v[184:187], v21 offset:37504
  ds_read_b128 v[188:191], v21 offset:38016
  ds_read_b128 v[168:171], v7 offset:26112
  ds_read_b128 v[172:175], v7 offset:26128
  ds_read_b128 v[176:179], v7 offset:26624
  ds_read_b128 v[180:183], v7 offset:26640
  v_add_u32 v21, 1024, v21
  v_add_u32 v7, 1024, v7
  v_mfma_f32_16x16x32_bf16 v[88:91], v[120:123], v[192:195], v[88:91]
  v_mfma_f32_16x16x32_bf16 v[92:95], v[124:127], v[192:195], v[92:95]
  v_mfma_f32_16x16x32_bf16 v[96:99], v[128:131], v[192:195], v[96:99]
  v_mfma_f32_16x16x32_bf16 v[100:103], v[132:135], v[192:195], v[100:103]
  v_mfma_f32_16x16x32_bf16 v[104:107], v[136:139], v[192:195], v[104:107]
  v_mfma_f32_16x16x32_bf16 v[108:111], v[140:143], v[192:195], v[108:111]
  v_mfma_f32_16x16x32_bf16 v[112:115], v[144:147], v[192:195], v[112:115]
  v_mfma_f32_16x16x32_bf16 v[116:119], v[148:151], v[192:195], v[116:119]
  s_waitcnt lgkmcnt(0)
  s_or_b32 s54, s72, vcc_lo
  s_cbranch_execz L_vlast
  s_cbranch_scc0 L_restart
L_vlast:
  s_mov_b64 s[36:37], s[26:27]
  s_mov_b32 s38, 131072
  s_waitcnt vmcnt(14) lgkmcnt(0)
  v_cvt_f32_i32 v152, v24
  v_cvt_f32_i32 v153, v25
  v_cvt_f32_i32 v154, v26
  v_cvt_f32_i32 v155, v27
  v_cvt_f32_i32 v156, v32
  v_cvt_f32_i32 v157, v33
  v_cvt_f32_i32 v158, v34
  v_cvt_f32_i32 v159, v35
  v_pk_fma_f32 v[152:153], v[152:153], v[168:169], v[168:169] op_sel:[0,0,1] op_sel_hi:[1,0,1]
  v_pk_fma_f32 v[154:155], v[154:155], v[168:169], v[168:169] op_sel:[0,0,1] op_sel_hi:[1,0,1]
  v_pk_fma_f32 v[156:157], v[156:157], v[170:171], v[170:171] op_sel:[0,0,1] op_sel_hi:[1,0,1]
  v_pk_fma_f32 v[158:159], v[158:159], v[170:171], v[170:171] op_sel:[0,0,1] op_sel_hi:[1,0,1]
  v_cvt_pk_bf16_f32 v120, v152, v156
  v_cvt_pk_bf16_f32 v124, v153, v157
  v_cvt_pk_bf16_f32 v128, v154, v158
  v_cvt_pk_bf16_f32 v132, v155, v159
  v_fma_f32 v184, v184, s53, -v8
  v_fma_f32 v185, v185, s53, -v8
  v_fma_f32 v186, v186, s53, -v8
  v_fma_f32 v187, v187, s53, -v8
  v_fma_f32 v188, v188, s53, -v8
  v_fma_f32 v189, v189, s53, -v8
  v_fma_f32 v190, v190, s53, -v8
  v_fma_f32 v191, v191, s53, -v8
  v_exp_f32 v184, v184
  v_exp_f32 v185, v185
  v_exp_f32 v186, v186
  v_exp_f32 v187, v187
  v_exp_f32 v188, v188
  v_exp_f32 v189, v189
  v_exp_f32 v190, v190
  v_exp_f32 v191, v191
  s_waitcnt vmcnt(12)
  v_cvt_f32_i32 v152, v28
  v_cvt_f32_i32 v153, v29
  v_cvt_f32_i32 v154, v30
  v_cvt_f32_i32 v155, v31
  v_cvt_f32_i32 v156, v36
  v_cvt_f32_i32 v157, v37
  v_cvt_f32_i32 v158, v38
  v_cvt_f32_i32 v159, v39
  v_pk_fma_f32 v[152:153], v[152:153], v[168:169], v[168:169] op_sel:[0,0,1] op_sel_hi:[1,0,1]
  v_pk_fma_f32 v[154:155], v[154:155], v[168:169], v[168:169] op_sel:[0,0,1] op_sel_hi:[1,0,1]
  v_pk_fma_f32 v[156:157], v[156:157], v[170:171], v[170:171] op_sel:[0,0,1] op_sel_hi:[1,0,1]
  v_pk_fma_f32 v[158:159], v[158:159], v[170:171], v[170:171] op_sel:[0,0,1] op_sel_hi:[1,0,1]
  v_cvt_pk_bf16_f32 v136, v152, v156
  v_cvt_pk_bf16_f32 v140, v153, v157
  v_cvt_pk_bf16_f32 v144, v154, v158
  v_cvt_pk_bf16_f32 v148, v155, v159
  v_cvt_pk_bf16_f32 v192, v184, v185
  v_cvt_pk_bf16_f32 v193, v186, v187
  v_cvt_pk_bf16_f32 v194, v188, v189
  v_cvt_pk_bf16_f32 v195, v190, v191
  v_pk_add_f32 v[184:185], v[184:185], v[186:187]
  v_pk_add_f32 v[188:189], v[188:189], v[190:191]
  v_pk_add_f32 v[184:185], v[184:185], v[188:189]
  v_add_f32 v9, v9, v184
  v_add_f32 v9, v9, v185
  s_waitcnt vmcnt(10)
  v_cvt_f32_i32 v152, v40
  v_cvt_f32_i32 v153, v41
  v_cvt_f32_i32 v154, v42
  v_cvt_f32_i32 v155, v43
  v_cvt_f32_i32 v156, v48
  v_cvt_f32_i32 v157, v49
  v_cvt_f32_i32 v158, v50
  v_cvt_f32_i32 v159, v51
  v_pk_fma_f32 v[152:153], v[152:153], v[172:173], v[172:173] op_sel:[0,0,1] op_sel_hi:[1,0,1]
  v_pk_fma_f32 v[154:155], v[154:155], v[172:173], v[172:173] op_sel:[0,0,1] op_sel_hi:[1,0,1]
  v_pk_fma_f32 v[156:157], v[156:157], v[174:175], v[174:175] op_sel:[0,0,1] op_sel_hi:[1,0,1]
  v_pk_fma_f32 v[158:159], v[158:159], v[174:175], v[174:175] op_sel:[0,0,1] op_sel_hi:[1,0,1]
  v_cvt_pk_bf16_f32 v121, v152, v156
  v_cvt_pk_bf16_f32 v125, v153, v157
  v_cvt_pk_bf16_f32 v129, v154, v158
  v_cvt_pk_bf16_f32 v133, v155, v159
  v_mov_b32 v14, v9
  v_lshlrev_b32 v13, 3, v0
  v_cmp_lt_u32 s[68:69], 7, v1
  v_permlane32_swap_b32 v9, v14
  v_add_f32 v9, v9, v14
  v_mov_b32 v14, v9
  s_nop 1
  v_permlane16_swap_b32 v9, v14
  v_add_f32 v9, v9, v14
  ds_write_b64 v18, v[8:9] offset:4224
  s_waitcnt vmcnt(8)
  v_cvt_f32_i32 v152, v44
  v_cvt_f32_i32 v153, v45
  v_cvt_f32_i32 v154, v46
  v_cvt_f32_i32 v155, v47
  v_cvt_f32_i32 v156, v52
  v_cvt_f32_i32 v157, v53
  v_cvt_f32_i32 v158, v54
  v_cvt_f32_i32 v159, v55
  v_pk_fma_f32 v[152:153], v[152:153], v[172:173], v[172:173] op_sel:[0,0,1] op_sel_hi:[1,0,1]
  v_pk_fma_f32 v[154:155], v[154:155], v[172:173], v[172:173] op_sel:[0,0,1] op_sel_hi:[1,0,1]
  v_pk_fma_f32 v[156:157], v[156:157], v[174:175], v[174:175] op_sel:[0,0,1] op_sel_hi:[1,0,1]
  v_pk_fma_f32 v[158:159], v[158:159], v[174:175], v[174:175] op_sel:[0,0,1] op_sel_hi:[1,0,1]
  v_cvt_pk_bf16_f32 v137, v152, v156
  v_cvt_pk_bf16_f32 v141, v153, v157
  v_cvt_pk_bf16_f32 v145, v154, v158
  v_cvt_pk_bf16_f32 v149, v155, v159
  s_waitcnt vmcnt(6)
  v_cvt_f32_i32 v152, v56
  v_cvt_f32_i32 v153, v57
  v_cvt_f32_i32 v154, v58
  v_cvt_f32_i32 v155, v59
  v_cvt_f32_i32 v156, v64
  v_cvt_f32_i32 v157, v65
  v_cvt_f32_i32 v158, v66
  v_cvt_f32_i32 v159, v67
  v_pk_fma_f32 v[152:153], v[152:153], v[176:177], v[176:177] op_sel:[0,0,1] op_sel_hi:[1,0,1]
  v_pk_fma_f32 v[154:155], v[154:155], v[176:177], v[176:177] op_sel:[0,0,1] op_sel_hi:[1,0,1]
  v_pk_fma_f32 v[156:157], v[156:157], v[178:179], v[178:179] op_sel:[0,0,1] op_sel_hi:[1,0,1]
  v_pk_fma_f32 v[158:159], v[158:159], v[178:179], v[178:179] op_sel:[0,0,1] op_sel_hi:[1,0,1]
  v_cvt_pk_bf16_f32 v122, v152, v156
  v_cvt_pk_bf16_f32 v126, v153, v157
  v_cvt_pk_bf16_f32 v130, v154, v158
  v_cvt_pk_bf16_f32 v134, v155, v159
  s_waitcnt vmcnt(4)
  v_cvt_f32_i32 v152, v60
  v_cvt_f32_i32 v153, v61
  v_cvt_f32_i32 v154, v62
  v_cvt_f32_i32 v155, v63
  v_cvt_f32_i32 v156, v68
  v_cvt_f32_i32 v157, v69
  v_cvt_f32_i32 v158, v70
  v_cvt_f32_i32 v159, v71
  v_pk_fma_f32 v[152:153], v[152:153], v[176:177], v[176:177] op_sel:[0,0,1] op_sel_hi:[1,0,1]
  v_pk_fma_f32 v[154:155], v[154:155], v[176:177], v[176:177] op_sel:[0,0,1] op_sel_hi:[1,0,1]
  v_pk_fma_f32 v[156:157], v[156:157], v[178:179], v[178:179] op_sel:[0,0,1] op_sel_hi:[1,0,1]
  v_pk_fma_f32 v[158:159], v[158:159], v[178:179], v[178:179] op_sel:[0,0,1] op_sel_hi:[1,0,1]
  v_cvt_pk_bf16_f32 v138, v152, v156
  v_cvt_pk_bf16_f32 v142, v153, v157
  v_cvt_pk_bf16_f32 v146, v154, v158
  v_cvt_pk_bf16_f32 v150, v155, v159
  s_waitcnt vmcnt(2)
  v_cvt_f32_i32 v152, v72
  v_cvt_f32_i32 v153, v73
  v_cvt_f32_i32 v154, v74
  v_cvt_f32_i32 v155, v75
  v_cvt_f32_i32 v156, v80
  v_cvt_f32_i32 v157, v81
  v_cvt_f32_i32 v158, v82
  v_cvt_f32_i32 v159, v83
  v_pk_fma_f32 v[152:153], v[152:153], v[180:181], v[180:181] op_sel:[0,0,1] op_sel_hi:[1,0,1]
  v_pk_fma_f32 v[154:155], v[154:155], v[180:181], v[180:181] op_sel:[0,0,1] op_sel_hi:[1,0,1]
  v_pk_fma_f32 v[156:157], v[156:157], v[182:183], v[182:183] op_sel:[0,0,1] op_sel_hi:[1,0,1]
  v_pk_fma_f32 v[158:159], v[158:159], v[182:183], v[182:183] op_sel:[0,0,1] op_sel_hi:[1,0,1]
  v_cvt_pk_bf16_f32 v123, v152, v156
  v_cvt_pk_bf16_f32 v127, v153, v157
  v_cvt_pk_bf16_f32 v131, v154, v158
  v_cvt_pk_bf16_f32 v135, v155, v159
  s_nop 1
  v_mfma_f32_16x16x32_bf16 v[88:91], v[120:123], v[192:195], v[88:91]
  v_mfma_f32_16x16x32_bf16 v[92:95], v[124:127], v[192:195], v[92:95]
  v_mfma_f32_16x16x32_bf16 v[96:99], v[128:131], v[192:195], v[96:99]
  v_mfma_f32_16x16x32_bf16 v[100:103], v[132:135], v[192:195], v[100:103]
  s_waitcnt vmcnt(0)
  v_cvt_f32_i32 v152, v76
  v_cvt_f32_i32 v153, v77
  v_cvt_f32_i32 v154, v78
  v_cvt_f32_i32 v155, v79
  v_cvt_f32_i32 v156, v84
  v_cvt_f32_i32 v157, v85
  v_cvt_f32_i32 v158, v86
  v_cvt_f32_i32 v159, v87
  v_pk_fma_f32 v[152:153], v[152:153], v[180:181], v[180:181] op_sel:[0,0,1] op_sel_hi:[1,0,1]
  v_pk_fma_f32 v[154:155], v[154:155], v[180:181], v[180:181] op_sel:[0,0,1] op_sel_hi:[1,0,1]
  v_pk_fma_f32 v[156:157], v[156:157], v[182:183], v[182:183] op_sel:[0,0,1] op_sel_hi:[1,0,1]
  v_pk_fma_f32 v[158:159], v[158:159], v[182:183], v[182:183] op_sel:[0,0,1] op_sel_hi:[1,0,1]
  v_cvt_pk_bf16_f32 v139, v152, v156
  v_cvt_pk_bf16_f32 v143, v153, v157
  v_cvt_pk_bf16_f32 v147, v154, v158
  v_cvt_pk_bf16_f32 v151, v155, v159
  s_nop 1
  v_mfma_f32_16x16x32_bf16 v[104:107], v[136:139], v[192:195], v[104:107]
  v_mfma_f32_16x16x32_bf16 v[108:111], v[140:143], v[192:195], v[108:111]
  v_mfma_f32_16x16x32_bf16 v[112:115], v[144:147], v[192:195], v[112:115]
  v_mfma_f32_16x16x32_bf16 v[116:119], v[148:151], v[192:195], v[116:119]
  s_nop 4
  v_cndmask_b32 v152, v88, v104, s[68:69]
  v_cndmask_b32 v153, v92, v108, s[68:69]
  v_cndmask_b32 v154, v96, v112, s[68:69]
  v_cndmask_b32 v155, v100, v116, s[68:69]
  ds_write_b128 v17, v[152:155] offset:0
  v_cndmask_b32 v156, v89, v105, s[68:69]
  v_cndmask_b32 v157, v93, v109, s[68:69]
  v_cndmask_b32 v158, v97, v113, s[68:69]
  v_cndmask_b32 v159, v101, v117, s[68:69]
  ds_write_b128 v17, v[156:159] offset:16
  v_cndmask_b32 v160, v90, v106, s[68:69]
  v_cndmask_b32 v161, v94, v110, s[68:69]
  v_cndmask_b32 v162, v98, v114, s[68:69]
  v_cndmask_b32 v163, v102, v118, s[68:69]
  ds_write_b128 v17, v[160:163] offset:32
  v_cndmask_b32 v164, v91, v107, s[68:69]
  v_cndmask_b32 v165, v95, v111, s[68:69]
  v_cndmask_b32 v166, v99, v115, s[68:69]
  v_cndmask_b32 v167, v103, v119, s[68:69]
  ds_write_b128 v17, v[164:167] offset:48
  s_cbranch_execz L_hopa
  s_waitcnt lgkmcnt(0)
  s_barrier
  buffer_load_dwordx2 v[24:25], v16, s[56:59], s65 offen offset:512 sc1
  buffer_load_dwordx4 v[32:35], v15, s[56:59], s65 offen sc1
  buffer_load_dwordx2 v[26:27], v16, s[56:59], s66 offen offset:512 sc1
  buffer_load_dwordx4 v[36:39], v15, s[56:59], s66 offen sc1
  buffer_load_dwordx2 v[28:29], v16, s[56:59], s67 offen offset:512 sc1
  buffer_load_dwordx4 v[40:43], v15, s[56:59], s67 offen sc1
L_hopa:
  ds_read_b64 v[64:65], v20 offset:4224
  ds_read_b64 v[66:67], v20 offset:8576
  ds_read_b64 v[68:69], v20 offset:12928
  ds_read_b64 v[70:71], v20 offset:17280
  ds_read_b128 v[72:75], v19 offset:0
  ds_read_b128 v[76:79], v19 offset:4352
  ds_read_b128 v[80:83], v19 offset:8704
  ds_read_b128 v[84:87], v19 offset:13056
  s_waitcnt lgkmcnt(4)
  v_max3_f32 v8, v64, v66, v68
  v_max_f32 v8, v8, v70
  v_sub_f32 v64, v64, v8
  v_sub_f32 v66, v66, v8
  v_sub_f32 v68, v68, v8
  v_sub_f32 v70, v70, v8
  v_exp_f32 v64, v64
  v_exp_f32 v66, v66
  v_exp_f32 v68, v68
  v_exp_f32 v70, v70
  v_mul_f32 v9, v64, v65
  v_fma_f32 v9, v66, v67, v9
  v_fma_f32 v9, v68, v69, v9
  v_fma_f32 v9, v70, v71, v9
  s_waitcnt lgkmcnt(0)
  v_pk_mul_f32 v[44:45], v[72:73], v[64:65] op_sel_hi:[1,0]
  v_pk_mul_f32 v[46:47], v[74:75], v[64:65] op_sel_hi:[1,0]
  v_pk_fma_f32 v[44:45], v[76:77], v[66:67], v[44:45] op_sel_hi:[1,0,1]
  v_pk_fma_f32 v[46:47], v[78:79], v[66:67], v[46:47] op_sel_hi:[1,0,1]
  v_pk_fma_f32 v[44:45], v[80:81], v[68:69], v[44:45] op_sel_hi:[1,0,1]
  v_pk_fma_f32 v[46:47], v[82:83], v[68:69], v[46:47] op_sel_hi:[1,0,1]
  v_pk_fma_f32 v[44:45], v[84:85], v[70:71], v[44:45] op_sel_hi:[1,0,1]
  v_pk_fma_f32 v[46:47], v[86:87], v[70:71], v[46:47] op_sel_hi:[1,0,1]
  v_min_u32 v8, -2, v8
  v_min_u32 v9, -2, v9
  v_min_u32 v44, -2, v44
  v_min_u32 v45, -2, v45
  v_min_u32 v46, -2, v46
  v_min_u32 v47, -2, v47
  s_cbranch_execz L_hopb
  buffer_store_dwordx4 v[44:47], v15, s[56:59], s64 offen sc1
  s_mov_b32 exec_lo, 1
  s_mov_b32 exec_hi, 1
  buffer_store_dwordx2 v[8:9], v16, s[56:59], s64 offen offset:512 sc1
  s_mov_b64 exec, -1
  s_cmp_eq_u32 s72, 0
  s_cbranch_scc1 L_slow
  s_waitcnt vmcnt(2)
L_hopb:
  v_max3_u32 v48, v24, v25, v26
  v_max3_u32 v49, v27, v28, v29
  v_max3_u32 v50, v32, v33, v34
  v_max3_u32 v51, v35, v36, v37
  v_max3_u32 v52, v38, v39, v40
  v_max3_u32 v53, v41, v42, v43
  v_max3_u32 v48, v48, v49, v50
  v_max3_u32 v51, v51, v52, v53
  v_max_u32 v48, v48, v51
  v_cmp_eq_u32 vcc, -1, v48
  s_cbranch_execz L_final
  s_cbranch_vccnz L_late
L_final:
  v_max3_f32 v12, v8, v24, v26
  v_max_f32 v12, v12, v28
  v_sub_f32 v48, v8, v12
  v_sub_f32 v50, v24, v12
  v_sub_f32 v52, v26, v12
  v_sub_f32 v54, v28, v12
  v_exp_f32 v48, v48
  v_exp_f32 v50, v50
  v_exp_f32 v52, v52
  v_exp_f32 v54, v54
  v_mul_f32 v49, v48, v9
  v_mul_f32 v51, v50, v25
  v_mul_f32 v53, v52, v27
  v_mul_f32 v55, v54, v29
  v_add_f32 v49, v49, v51
  v_add_f32 v53, v53, v55
  v_add_f32 v49, v49, v53
  v_rcp_f32 v10, v49
  v_pk_mul_f32 v[152:153], v[44:45], v[48:49] op_sel_hi:[1,0]
  v_pk_mul_f32 v[154:155], v[46:47], v[48:49] op_sel_hi:[1,0]
  v_pk_mul_f32 v[156:157], v[32:33], v[50:51] op_sel_hi:[1,0]
  v_pk_mul_f32 v[158:159], v[34:35], v[50:51] op_sel_hi:[1,0]
  v_pk_mul_f32 v[160:161], v[36:37], v[52:53] op_sel_hi:[1,0]
  v_pk_mul_f32 v[162:163], v[38:39], v[52:53] op_sel_hi:[1,0]
  v_pk_mul_f32 v[164:165], v[40:41], v[54:55] op_sel_hi:[1,0]
  v_pk_mul_f32 v[166:167], v[42:43], v[54:55] op_sel_hi:[1,0]
  v_pk_add_f32 v[152:153], v[152:153], v[156:157]
  v_pk_add_f32 v[154:155], v[154:155], v[158:159]
  v_pk_add_f32 v[160:161], v[160:161], v[164:165]
  v_pk_add_f32 v[162:163], v[162:163], v[166:167]
  v_pk_add_f32 v[152:153], v[152:153], v[160:161]
  v_pk_add_f32 v[154:155], v[154:155], v[162:163]
  v_pk_mul_f32 v[152:153], v[152:153], v[10:11] op_sel_hi:[1,0]
  v_pk_mul_f32 v[154:155], v[154:155], v[10:11] op_sel_hi:[1,0]
  v_cvt_pk_bf16_f32 v192, v152, v153
  v_cvt_pk_bf16_f32 v193, v154, v155
  s_cbranch_execz L_walked
  buffer_store_dwordx2 v[192:193], v13, s[36:39], s71 offen
L_done:
L_end:
  s_endpgm
L_late:
  s_waitcnt vmcnt(0)
L_reload:
  buffer_load_dwordx2 v[24:25], v16, s[56:59], s65 offen offset:512 sc1
  buffer_load_dwordx4 v[32:35], v15, s[56:59], s65 offen sc1
  buffer_load_dwordx2 v[26:27], v16, s[56:59], s66 offen offset:512 sc1
  buffer_load_dwordx4 v[36:39], v15, s[56:59], s66 offen sc1
  buffer_load_dwordx2 v[28:29], v16, s[56:59], s67 offen offset:512 sc1
  buffer_load_dwordx4 v[40:43], v15, s[56:59], s67 offen sc1
  s_waitcnt vmcnt(0)
  v_max3_u32 v48, v24, v25, v26
  v_max3_u32 v49, v27, v28, v29
  v_max3_u32 v50, v32, v33, v34
  v_max3_u32 v51, v35, v36, v37
  v_max3_u32 v52, v38, v39, v40
  v_max3_u32 v53, v41, v42, v43
  v_max3_u32 v48, v48, v49, v50
  v_max3_u32 v51, v51, v52, v53
  v_max_u32 v48, v48, v51
  v_cmp_eq_u32 vcc, -1, v48
  s_cbranch_vccz L_final
  s_endpgm
L_slow:
  v_mov_b32 v14, 0
  s_waitcnt vmcnt(0)
  global_load_dword v48, v14, s[28:29] offset:252 sc1
  s_waitcnt vmcnt(0)
  v_readfirstlane_b32 s54, v48
  s_nop 3
  s_cmp_eq_u32 s54, 1
  s_cbranch_scc1 L_reload
  s_lshl2_add_u32 s54, s60, s3
  s_and_b32 s55, s54, 7
  s_lshl_b32 s55, s55, 2
  s_lshr_b32 s54, s54, 3
  s_lshl_b32 s54, s54, 2
  v_mov_b32 v14, s54
  s_lshl_b32 s54, 1, s55
  v_mov_b32 v48, s54
  s_mov_b64 exec, 1
  global_atomic_add v48, v14, v48, s[28:29] sc0 sc1
  s_waitcnt vmcnt(0)
  v_readfirstlane_b32 s54, v48
  s_mov_b64 exec, -1
  s_nop 3
  s_lshr_b32 s54, s54, s55
  s_and_b32 s54, s54, 15
  s_cmp_eq_u32 s54, 3
  s_cbranch_scc1 L_reload
  s_endpgm
L_restart:
  s_waitcnt vmcnt(0)
  s_mov_b32 s63, s49
  s_add_u32 s62, s62, 0x20000
  s_and_b32 s62, s62, 0x1fffff
  s_add_u32 s48, s62, s61
  s_lshr_b32 s49, s62, 1
  buffer_load_dwordx4 v[88:91], v3, s[32:35], s48 offen offset:0 nt
  buffer_load_dwordx2 v[120:121], v4, s[40:43], s49 offen offset:0
  buffer_load_dwordx4 v[92:95], v3, s[32:35], s48 offen offset:256 nt
  buffer_load_dwordx2 v[122:123], v4, s[44:47], s49 offen offset:0
  buffer_load_dwordx4 v[96:99], v3, s[32:35], s48 offen offset:512 nt
  buffer_load_dwordx2 v[124:125], v4, s[40:43], s49 offen offset:256
  buffer_load_dwordx4 v[100:103], v3, s[32:35], s48 offen offset:768 nt
  buffer_load_dwordx2 v[126:127], v4, s[44:47], s49 offen offset:256
  buffer_load_dwordx4 v[104:107], v3, s[32:35], s48 offen offset:1024 nt
  buffer_load_dwordx2 v[128:129], v4, s[40:43], s49 offen offset:512
  buffer_load_dwordx4 v[108:111], v3, s[32:35], s48 offen offset:1280 nt
  buffer_load_dwordx2 v[130:131], v4, s[44:47], s49 offen offset:512
  buffer_load_dwordx4 v[112:115], v3, s[32:35], s48 offen offset:1536 nt
  buffer_load_dwordx2 v[132:133], v4, s[40:43], s49 offen offset:768
  buffer_load_dwordx4 v[116:119], v3, s[32:35], s48 offen offset:1792 nt
  buffer_load_dwordx2 v[134:135], v4, s[44:47], s49 offen offset:768
  s_mov_b32 s63, s49
  s_add_u32 s62, s62, 0x20000
  s_and_b32 s62, s62, 0x1fffff
  s_add_u32 s48, s62, s61
  s_lshr_b32 s49, s62, 1
  v_subrev_u32 v21, 8192, v21
  v_subrev_u32 v7, 8192, v7
  ds_read_b128 v[140:143], v7 offset:17408
  ds_read_b128 v[144:147], v7 offset:17424
  v_add_u32 v7, 512, v7
  ds_read_b128 v[148:151], v22 offset:35328
  ds_read_b128 v[152:155], v22 offset:35344
  ds_read_b128 v[156:159], v22 offset:35360
  ds_read_b128 v[160:163], v22 offset:35376
  v_mov_b32 v8, 0xff61b1e6
  s_mov_b32 s50, 16
  s_mov_b32 s73, 0
  s_mov_b64 vcc, -1
  s_branch L_kloop
L_both0:
  buffer_load_dwordx2 v[136:137], v4, s[40:43], s63 offen offset:128
  buffer_load_dwordx2 v[138:139], v4, s[44:47], s63 offen offset:128
  s_waitcnt vmcnt(0)
  v_perm_b32 v176, v136, v138, s51
  v_perm_b32 v177, v136, v138, s52
  v_perm_b32 v178, v137, v139, s51
  v_perm_b32 v179, v137, v139, s52
  s_branch L_back0
L_both1:
  buffer_load_dwordx2 v[136:137], v4, s[40:43], s63 offen offset:384
  buffer_load_dwordx2 v[138:139], v4, s[44:47], s63 offen offset:384
  s_waitcnt vmcnt(0)
  v_perm_b32 v176, v136, v138, s51
  v_perm_b32 v177, v136, v138, s52
  v_perm_b32 v178, v137, v139, s51
  v_perm_b32 v179, v137, v139, s52
  s_branch L_back1
L_both2:
  buffer_load_dwordx2 v[136:137], v4, s[40:43], s63 offen offset:640
  buffer_load_dwordx2 v[138:139], v4, s[44:47], s63 offen offset:640
  s_waitcnt vmcnt(0)
  v_perm_b32 v176, v136, v138, s51
  v_perm_b32 v177, v136, v138, s52
  v_perm_b32 v178, v137, v139, s51
  v_perm_b32 v179, v137, v139, s52
  s_branch L_back2
L_both3:
  buffer_load_dwordx2 v[136:137], v4, s[40:43], s63 offen offset:896
  buffer_load_dwordx2 v[138:139], v4, s[44:47], s63 offen offset:896
  s_waitcnt vmcnt(0)
  v_perm_b32 v176, v136, v138, s51
  v_perm_b32 v177, v136, v138, s52
  v_perm_b32 v178, v137, v139, s51
  v_perm_b32 v179, v137, v139, s52
  s_branch L_back3
L_kgeneral:
  s_waitcnt vmcnt(0) lgkmcnt(0)
  v_subrev_u32 v7, 512, v7
  s_lshl_b32 s70, s63, 1
  s_add_u32 s70, s70, s61
  buffer_load_dwordx4 v[24:27], v3, s[36:39], s70 offen offset:0 nt
  buffer_load_dwordx4 v[32:35], v3, s[36:39], s70 offen offset:512 nt
  buffer_load_dwordx4 v[28:31], v3, s[36:39], s70 offen offset:256 nt
  buffer_load_dwordx4 v[36:39], v3, s[36:39], s70 offen offset:768 nt
  buffer_load_dwordx4 v[40:43], v3, s[36:39], s70 offen offset:1024 nt
  buffer_load_dwordx4 v[48:51], v3, s[36:39], s70 offen offset:1536 nt
  buffer_load_dwordx4 v[44:47], v3, s[36:39], s70 offen offset:1280 nt
  buffer_load_dwordx4 v[52:55], v3, s[36:39], s70 offen offset:1792 nt
  buffer_load_dwordx4 v[56:59], v3, s[36:39], s48 offen offset:0 nt
  buffer_load_dwordx4 v[64:67], v3, s[36:39], s48 offen offset:512 nt
  buffer_load_dwordx4 v[60:63], v3, s[36:39], s48 offen offset:256 nt
  buffer_load_dwordx4 v[68:71], v3, s[36:39], s48 offen offset:768 nt
  buffer_load_dwordx4 v[72:75], v3, s[36:39], s48 offen offset:1024 nt
  buffer_load_dwordx4 v[80:83], v3, s[36:39], s48 offen offset:1536 nt
  buffer_load_dwordx4 v[76:79], v3, s[36:39], s48 offen offset:1280 nt
  buffer_load_dwordx4 v[84:87], v3, s[36:39], s48 offen offset:1792 nt
  s_branch L_kdone
L_helper:
  s_setprio 3
  v_and_b32 v13, 63, v0
  v_lshrrev_b32 v22, 1, v13
  v_mul_u32_u24 v22, 4352, v22
  v_and_b32 v14, 1, v13
  v_lshl_add_u32 v22, v14, 4, v22
  s_lshr_b32 s66, s2, 3
  s_mul_i32 s66, s66, 4352
  s_and_b32 s54, s2, 7
  s_lshl2_add_u32 s66, s54, s66
  s_mov_b32 s67, 1310720
  s_add_u32 s66, s66, s67
  s_mov_b32 s58, 1449984
  s_mov_b32 s59, 0x20000
  s_cmp_lg_u32 s2, 0
  s_waitcnt lgkmcnt(0)
  s_mov_b64 s[56:57], s[30:31]
  s_cbranch_scc1 L_nosnap
  buffer_load_dwordx4 v[24:27], v22, s[56:59], s67 offen sc1
L_nosnap:
  buffer_load_dword v15, off, s[56:59], s66 sc1
  v_lshrrev_b32 v14, 3, v13
  v_lshlrev_b32 v13, 4, v13
  v_lshl_add_u32 v14, v14, 7, v13
  v_mov_b32 v180, -1
  v_mov_b32 v181, -1
  v_mov_b32 v182, -1
  v_mov_b32 v183, -1
  s_mul_i32 s64, s2, 5120
  s_add_u32 s54, s64, 1024
  buffer_store_dwordx4 v[180:183], v13, s[56:59], s64 offen sc1
  buffer_store_dwordx4 v[180:183], v13, s[56:59], s54 offen offset:0 sc1
  buffer_store_dwordx4 v[180:183], v13, s[56:59], s54 offen offset:1024 sc1
  buffer_store_dwordx4 v[180:183], v13, s[56:59], s54 offen offset:2048 sc1
  buffer_store_dwordx4 v[180:183], v13, s[56:59], s54 offen offset:3072 sc1
  s_andn2_b32 s54, s2, 15
  s_and_b32 s55, s2, 3
  s_lshl2_add_u32 s54, s55, s54
  s_bfe_u32 s55, s2, 0x20002
  s_add_u32 s54, s54, s55
  s_lshl_b32 s54, s54, 12
  v_add_u32 v14, s54, v14
  global_load_dwordx4 v[32:35], v14, s[22:23] offset:0
  global_load_dwordx4 v[36:39], v14, s[22:23] offset:128
  global_load_dwordx4 v[40:43], v14, s[22:23] offset:2048
  global_load_dwordx4 v[44:47], v14, s[22:23] offset:2176
  global_load_dwordx4 v[48:51], v14, s[24:25] offset:0
  global_load_dwordx4 v[52:55], v14, s[24:25] offset:128
  global_load_dwordx4 v[56:59], v14, s[24:25] offset:2048
  global_load_dwordx4 v[60:63], v14, s[24:25] offset:2176
  s_barrier
  s_setprio 0
  s_mov_b64 exec, 0
  s_branch L_walk
L_walked:
  s_mov_b64 exec, -1
  s_setprio 3
  s_waitcnt vmcnt(0)
  s_mov_b64 s[68:69], 0
  v_cmp_ne_u64 vcc, v[32:33], v[36:37]
  s_or_b64 s[68:69], s[68:69], vcc
  v_cmp_ne_u64 vcc, v[34:35], v[38:39]
  s_or_b64 s[68:69], s[68:69], vcc
  v_cmp_ne_u64 vcc, v[40:41], v[44:45]
  s_or_b64 s[68:69], s[68:69], vcc
  v_cmp_ne_u64 vcc, v[42:43], v[46:47]
  s_or_b64 s[68:69], s[68:69], vcc
  v_cmp_ne_u64 vcc, v[48:49], v[52:53]
  s_or_b64 s[68:69], s[68:69], vcc
  v_cmp_ne_u64 vcc, v[50:51], v[54:55]
  s_or_b64 s[68:69], s[68:69], vcc
  v_cmp_ne_u64 vcc, v[56:57], v[60:61]
  s_or_b64 s[68:69], s[68:69], vcc
  v_cmp_ne_u64 vcc, v[58:59], v[62:63]
  s_or_b64 s[68:69], s[68:69], vcc
  s_cbranch_scc1 L_end
  v_add_u32 v15, 1, v15
  s_mov_b64 exec, 1
  buffer_store_dword v15, off, s[56:59], s66 sc1
  s_mov_b64 exec, -1
  s_cmp_lg_u32 s2, 0
  s_cbranch_scc1 L_end
  s_mov_b32 s50, 24
  s_waitcnt vmcnt(0)
L_watch:
  buffer_load_dwordx4 v[28:31], v22, s[56:59], s67 offen sc1
  s_mov_b64 s[68:69], 0
  s_waitcnt vmcnt(0)
  v_cmp_eq_u32 vcc, v24, v28
  s_or_b64 s[68:69], s[68:69], vcc
  v_cmp_eq_u32 vcc, v25, v29
  s_or_b64 s[68:69], s[68:69], vcc
  v_cmp_eq_u32 vcc, v26, v30
  s_or_b64 s[68:69], s[68:69], vcc
  v_cmp_eq_u32 vcc, v27, v31
  s_or_b64 s[68:69], s[68:69], vcc
  s_cbranch_scc0 L_goahead
  s_mov_b64 exec, s[68:69]
  s_sub_u32 s50, s50, 1
  s_cmp_lg_u32 s50, 0
  s_cbranch_scc1 L_watch
  s_endpgm
L_goahead:
  s_mov_b64 exec, 1
  v_mov_b32 v13, 0
  v_mov_b32 v14, 1
  global_store_dword v13, v14, s[28:29] offset:252 sc1
  s_endpgm
.section .rodata,"a"
.p2align 6
.amdhsa_kernel standalone__kv_cache_quant_pre_rope_vs_post_rope__sampling_kernel
  .amdhsa_next_free_vgpr 204
  .amdhsa_next_free_sgpr 74
  .amdhsa_accum_offset 204
  .amdhsa_group_segment_fixed_size 0
  .amdhsa_kernarg_size 112
  .amdhsa_user_sgpr_count 2
  .amdhsa_user_sgpr_kernarg_segment_ptr 1
  .amdhsa_system_sgpr_workgroup_id_x 1
  .amdhsa_float_denorm_mode_32 3
.end_amdhsa_kernel
```
